```python
import torch

def _softmax(x, axis=-1):
    return torch.softmax(x, dim=axis)
def _gelu(x):
    return torch.nn.functional.gelu(x, approximate="tanh")
def _silu(x):
    return torch.nn.functional.silu(x)
def _sigmoid(x):
    return torch.sigmoid(x)
def _layernorm(x, axis=-1, eps=1e-5):
    m = x.mean(dim=axis, keepdim=True)
    v = x.var(dim=axis, keepdim=True, unbiased=False)
    return (x - m) / torch.sqrt(v + eps)
def _scatter_add(tgt, idx, src, axis=0):
    return tgt.clone().index_add_(axis, idx, src)
def _segment_sum(src, seg, n):
    out = torch.zeros((n,) + src.shape[1:], dtype=src.dtype)
    return out.index_add_(0, seg, src)
def _pad(x, pw):
    flat = tuple(v for pair in reversed(pw) for v in pair)
    return torch.nn.functional.pad(x, flat)

kernel_name = 'gated_mix__mha_block_cached__glu_gated_geglu__decode'

def setup_inputs():

    _w = (lambda a: (lambda t: t.to(torch.bfloat16) if t.is_floating_point() else t)(torch.as_tensor(a)))
    def _A_setup():
        B, Sq, D = 4, 1, 640
        H, Sk, Dh = 32, 8192, 192
        return {
            "x": _w((lambda *s: torch.randn(*s, dtype=torch.bfloat16) * 0.05)(B, Sq, D)),
            "k_cache": _w((lambda *s: torch.randn(*s, dtype=torch.bfloat16) * 3.2)(B, H, Sk, Dh)),
            "v_cache": _w((lambda *s: torch.randn(*s, dtype=torch.bfloat16) * 0.05)(B, H, Sk, Dh)),
            "wq": _w((lambda *s: torch.randn(*s, dtype=torch.bfloat16) * 3.2)(D, H * Dh) * (D ** -0.5)),
            "wo": _w((lambda *s: torch.randn(*s, dtype=torch.bfloat16) * 0.05)(H * Dh, D) * ((H * Dh) ** -0.5)),
        }
    _A_in = _A_setup()

    def _B_setup():
        B, S, Dm, Df = 4, 1, 640, 1536
        return {
            "x": _w((lambda *s: torch.randn(*s, dtype=torch.bfloat16) * 0.05)(B, S, Dm)),
            "w_gate": _w((lambda *s: torch.randn(*s, dtype=torch.bfloat16) * 0.2)(Dm, Df) * (Dm ** -0.5)),
            "w_up": _w((lambda *s: torch.randn(*s, dtype=torch.bfloat16) * 0.2)(Dm, Df) * (Dm ** -0.5)),
            "w_down": _w((lambda *s: torch.randn(*s, dtype=torch.bfloat16) * 0.2)(Df, Dm) * (Df ** -0.5)),
        }
    _B_in = _B_setup()

    return {
        "A_x": _A_in["x"],
        "A_k_cache": _A_in["k_cache"],
        "A_v_cache": _A_in["v_cache"],
        "A_wq": _A_in["wq"],
        "A_wo": _A_in["wo"],
        "B_x": _B_in["x"],
        "B_w_gate": _B_in["w_gate"],
        "B_w_up": _B_in["w_up"],
        "B_w_down": _B_in["w_down"],
        "gate_w": _w((lambda *s: torch.randn(*s, dtype=torch.bfloat16) * 0.05)(640) * 16.0),
    }

def reference(A_x, A_k_cache, A_v_cache, A_wq, A_wo, B_x, B_w_gate, B_w_up, B_w_down, gate_w):
    def _A_ref(x, k_cache, v_cache, wq, wo):
        B, Sq, D = x.shape
        H, Dh = 32, 192
        q = (lambda x, *d: x.permute(*d))((x @ wq).reshape(B, Sq, H, Dh), 0, 2, 1, 3)
        scores = torch.einsum("bhqd,bhkd->bhqk", q, k_cache) * (Dh ** -0.5)
        p = _softmax(scores, axis=-1)
        o = torch.einsum("bhqk,bhkd->bhqd", p, v_cache)
        return (lambda x, *d: x.permute(*d))(o, 0, 2, 1, 3).reshape(B, Sq, H * Dh) @ wo

    def _B_ref(x, w_gate, w_up, w_down):
        g = torch.einsum("bsd,df->bsf", x, w_gate)
        u = torch.einsum("bsd,df->bsf", x, w_up)
        h = _gelu(g) * u
        return torch.einsum("bsf,fd->bsd", h, w_down)

    x = A_x
    g = _sigmoid((x * gate_w).sum(-1, keepdims=True))
    a = _A_ref(x, A_k_cache, A_v_cache, A_wq, A_wo)
    b = _B_ref(x, B_w_gate, B_w_up, B_w_down)
    return g * a + (1 - g) * b
```

```asm
; @launch grid=(256,1,1) block=(512,1,1) lds=86016
.amdgcn_target "amdgcn-amd-amdhsa--gfx950"
.text
.globl gated_mix__mha_block_cached__glu_gated_geglu__decode_kernel
.p2align 8
.type gated_mix__mha_block_cached__glu_gated_geglu__decode_kernel,@function
gated_mix__mha_block_cached__glu_gated_geglu__decode_kernel:
    s_cmp_ge_u32 s2, 256
    s_cbranch_scc1 L_end
    s_load_dwordx16 s[4:19], s[0:1], 0
    s_load_dwordx8 s[20:27], s[0:1], 64
    s_load_dwordx2 s[28:29], s[0:1], 96
    v_and_b32 v1, 63, v0
    v_lshrrev_b32 v52, 6, v0
    v_and_b32 v2, 15, v1
    v_lshrrev_b32 v3, 4, v1
    v_readfirstlane_b32 s30, v52
    s_and_b32 s59, s2, 3
    s_bfe_u32 s56, s2, 0x50002
    s_lshr_b32 s58, s2, 7
    s_lshl_b32 s57, s58, 2
    s_add_u32 s57, s57, s59
    s_lshr_b32 s60, s30, 2
    s_and_b32 s31, s30, 3
    s_lshl_b32 s61, s60, 1
    s_add_u32 s61, s61, s58
    s_lshl_b32 s62, s61, 5
    s_add_u32 s62, s62, s56
    s_mul_i32 s63, s62, 3145728
    s_mul_i32 s73, s31, 6144
    s_add_u32 s82, s63, s73
    s_lshl_b32 s72, s59, 5
    s_mov_b32 s95, 24576
    s_mov_b32 s67, 32
    s_mov_b32 s85, 32
    s_mov_b32 s79, 0
    s_cmp_eq_u32 s60, 0
    s_cbranch_scc1 L_b2_1
    s_mov_b32 s67, 1000
    s_mov_b32 s85, 1000
    s_cmp_eq_u32 s59, 0
    s_cbranch_scc1 L_b2_1
    s_add_u32 s72, s72, 8
    s_cmp_eq_u32 s59, 3
    s_cbranch_scc0 L_b2_1
    s_mov_b32 s72, 127
    s_mov_b32 s95, 0xffffa000
L_b2_1:
    s_mul_i32 s73, s72, 24576
    s_add_u32 s63, s82, s73
    s_sub_u32 s80, s63, 24576
    s_lshr_b32 s83, s2, 2
    s_lshl_b32 s83, s83, 6
    s_add_u32 s83, s83, 4325376
    s_add_u32 s73, s59, 1
    s_and_b32 s73, s73, 2
    s_cmp_eq_u32 s73, 0
    s_cselect_b32 s86, 5, 3
    s_mov_b32 s81, s63
    s_mov_b32 s84, 0
    s_mul_i32 s88, s56, 3
    s_add_u32 s88, s88, s57
    s_sub_u32 s88, s88, 5
    s_mul_i32 s90, s88, 43
    s_lshr_b32 s90, s90, 9
    s_mul_i32 s72, s90, 12
    s_sub_u32 s89, s88, s72
    s_mov_b32 s91, s57
    s_mov_b32 s92, s56
    s_mov_b32 s93, 0
    s_cmp_ge_u32 s57, 5
    s_cbranch_scc0 L_rd_3
    s_mov_b32 s91, s89
    s_add_u32 s92, s90, 32
    s_mov_b32 s93, 1
    s_cmp_ge_u32 s89, 5
    s_cbranch_scc0 L_rd_3
    s_mov_b32 s93, 2
L_rd_3:
    v_and_b32 v52, 3, v2
    v_lshrrev_b32 v53, 2, v2
    v_mul_u32_u24 v4, 768, v53
    v_lshl_add_u32 v4, v52, 4, v4
    v_lshl_add_u32 v4, v3, 6, v4
    v_mul_u32_u24 v5, 768, v3
    v_lshl_add_u32 v5, v2, 4, v5
    v_and_b32 v52, 1, v2
    v_cmp_ne_u32 s[68:69], 0, v52
    v_and_b32 v52, 2, v2
    v_cmp_ne_u32 s[70:71], 0, v52
    v_mov_b32 v53, 0xffff
    v_mov_b32 v54, 0xffff0000
    v_cndmask_b32 v53, v53, v54, s[68:69]
    v_bfe_u32 v52, v2, 1, 2
    v_cmp_eq_u32 vcc, 0, v52
    s_nop 1
    v_cndmask_b32 v6, 0, v53, vcc
    v_cmp_eq_u32 vcc, 1, v52
    s_nop 1
    v_cndmask_b32 v7, 0, v53, vcc
    v_cmp_eq_u32 vcc, 2, v52
    s_nop 1
    v_cndmask_b32 v8, 0, v53, vcc
    v_cmp_eq_u32 vcc, 3, v52
    s_nop 1
    v_cndmask_b32 v9, 0, v53, vcc
    s_mov_b32 s65, 0x3dd53b95
    s_mov_b32 s66, 0x41000000
    v_lshlrev_b32 v52, 2, v1
    v_add_u32 v52, 4096, v52
    v_mov_b32 v53, 0
    ds_write_b32 v52, v53
    v_mov_b32 v52, 768
    ds_write_b32 v52, v53 offset:0
    ds_write_b32 v52, v53 offset:4
    ds_write_b32 v52, v53 offset:8
    ds_write_b32 v52, v53 offset:12
    s_waitcnt lgkmcnt(0)
    s_barrier
    s_memrealtime s[96:97]
    s_mov_b32 s32, s6
    s_and_b32 s33, s7, 0xffff
    s_mov_b32 s34, 402653184
    s_mov_b32 s35, 0x20000
    s_mov_b32 s36, s8
    s_and_b32 s37, s9, 0xffff
    s_mov_b32 s38, 402653184
    s_mov_b32 s39, 0x20000
    s_mov_b32 s40, s28
    s_and_b32 s41, s29, 0xffff
    s_mov_b32 s42, 4456448
    s_mov_b32 s43, 0x20000
    s_mov_b32 s44, s10
    s_and_b32 s45, s11, 0xffff
    s_mov_b32 s46, 7864320
    s_mov_b32 s47, 0x20000
    s_mov_b32 s48, s4
    s_and_b32 s49, s5, 0xffff
    s_mov_b32 s50, 5120
    s_mov_b32 s51, 0x20000
    v_mov_b32 v10, 4259840
    buffer_load_dwordx2 v[10:11], v10, s[40:43], 0 offen sc1
    s_waitcnt lgkmcnt(0)
    s_mov_b32 s78, s96
    s_cmp_eq_u32 s60, 0
    s_cbranch_scc1 L_qphase
    buffer_load_dwordx4 v[64:67], v4, s[32:35], s63 offen offset:0 nt
    buffer_load_dwordx4 v[68:71], v4, s[32:35], s63 offen offset:256 nt
    buffer_load_dwordx4 v[72:75], v4, s[32:35], s63 offen offset:512 nt
    buffer_load_dwordx4 v[76:79], v4, s[32:35], s63 offen offset:3072 nt
    buffer_load_dwordx4 v[80:83], v4, s[32:35], s63 offen offset:3328 nt
    buffer_load_dwordx4 v[84:87], v4, s[32:35], s63 offen offset:3584 nt
    buffer_load_dwordx4 v[88:91], v5, s[36:39], s63 offen offset:0 nt
    buffer_load_dwordx4 v[92:95], v5, s[36:39], s63 offen offset:256 nt
    buffer_load_dwordx4 v[96:99], v5, s[36:39], s63 offen offset:512 nt
    buffer_load_dwordx4 v[100:103], v5, s[36:39], s63 offen offset:3072 nt
    buffer_load_dwordx4 v[104:107], v5, s[36:39], s63 offen offset:3328 nt
    buffer_load_dwordx4 v[108:111], v5, s[36:39], s63 offen offset:3584 nt
    s_add_u32 s81, s81, s95
    s_sub_u32 s67, s67, 1
    s_cmp_lg_u32 s67, 0
    s_cbranch_scc1 L_ar_4
    s_mov_b32 s67, s79
    s_mov_b32 s79, 0
    s_mov_b32 s81, s80
    s_mov_b32 s95, 0xffffa000
L_ar_4:
    s_cmp_gt_i32 s67, 0
    s_cselect_b32 s63, s81, 0x80000000
    buffer_load_dwordx4 v[112:115], v4, s[32:35], s63 offen offset:0 nt
    buffer_load_dwordx4 v[116:119], v4, s[32:35], s63 offen offset:256 nt
    buffer_load_dwordx4 v[120:123], v4, s[32:35], s63 offen offset:512 nt
    buffer_load_dwordx4 v[124:127], v4, s[32:35], s63 offen offset:3072 nt
    buffer_load_dwordx4 v[128:131], v4, s[32:35], s63 offen offset:3328 nt
    buffer_load_dwordx4 v[132:135], v4, s[32:35], s63 offen offset:3584 nt
    s_waitcnt vmcnt(12)
    buffer_load_dwordx4 v[136:139], v5, s[36:39], s63 offen offset:0 nt
    buffer_load_dwordx4 v[140:143], v5, s[36:39], s63 offen offset:256 nt
    buffer_load_dwordx4 v[144:147], v5, s[36:39], s63 offen offset:512 nt
    buffer_load_dwordx4 v[148:151], v5, s[36:39], s63 offen offset:3072 nt
    buffer_load_dwordx4 v[152:155], v5, s[36:39], s63 offen offset:3328 nt
    buffer_load_dwordx4 v[156:159], v5, s[36:39], s63 offen offset:3584 nt
    s_add_u32 s81, s81, s95
    s_sub_u32 s67, s67, 1
    s_cmp_lg_u32 s67, 0
    s_cbranch_scc1 L_ar_5
    s_mov_b32 s67, s79
    s_mov_b32 s79, 0
    s_mov_b32 s81, s80
    s_mov_b32 s95, 0xffffa000
L_ar_5:
    s_cmp_gt_i32 s67, 0
    s_cselect_b32 s63, s81, 0x80000000
    s_waitcnt vmcnt(12)
    buffer_load_dwordx4 v[160:163], v4, s[32:35], s63 offen offset:0 nt
    buffer_load_dwordx4 v[164:167], v4, s[32:35], s63 offen offset:256 nt
    buffer_load_dwordx4 v[168:171], v4, s[32:35], s63 offen offset:512 nt
    buffer_load_dwordx4 v[172:175], v4, s[32:35], s63 offen offset:3072 nt
    buffer_load_dwordx4 v[176:179], v4, s[32:35], s63 offen offset:3328 nt
    buffer_load_dwordx4 v[180:183], v4, s[32:35], s63 offen offset:3584 nt
    s_waitcnt vmcnt(12)
    buffer_load_dwordx4 v[184:187], v5, s[36:39], s63 offen offset:0 nt
    buffer_load_dwordx4 v[188:191], v5, s[36:39], s63 offen offset:256 nt
    buffer_load_dwordx4 v[192:195], v5, s[36:39], s63 offen offset:512 nt
    buffer_load_dwordx4 v[196:199], v5, s[36:39], s63 offen offset:3072 nt
    buffer_load_dwordx4 v[200:203], v5, s[36:39], s63 offen offset:3328 nt
    buffer_load_dwordx4 v[204:207], v5, s[36:39], s63 offen offset:3584 nt
    s_add_u32 s81, s81, s95
    s_sub_u32 s67, s67, 1
    s_cmp_lg_u32 s67, 0
    s_cbranch_scc1 L_ar_6
    s_mov_b32 s67, s79
    s_mov_b32 s79, 0
    s_mov_b32 s81, s80
    s_mov_b32 s95, 0xffffa000
L_ar_6:
    s_cmp_gt_i32 s67, 0
    s_cselect_b32 s63, s81, 0x80000000
    s_waitcnt vmcnt(12)
    buffer_load_dwordx4 v[208:211], v4, s[32:35], s63 offen offset:0 nt
    buffer_load_dwordx4 v[212:215], v4, s[32:35], s63 offen offset:256 nt
    buffer_load_dwordx4 v[216:219], v4, s[32:35], s63 offen offset:512 nt
    buffer_load_dwordx4 v[220:223], v4, s[32:35], s63 offen offset:3072 nt
    buffer_load_dwordx4 v[224:227], v4, s[32:35], s63 offen offset:3328 nt
    buffer_load_dwordx4 v[228:231], v4, s[32:35], s63 offen offset:3584 nt
    s_waitcnt vmcnt(12)
    buffer_load_dwordx4 v[232:235], v5, s[36:39], s63 offen offset:0 nt
    buffer_load_dwordx4 v[236:239], v5, s[36:39], s63 offen offset:256 nt
    buffer_load_dwordx4 v[240:243], v5, s[36:39], s63 offen offset:512 nt
    buffer_load_dwordx4 v[244:247], v5, s[36:39], s63 offen offset:3072 nt
    buffer_load_dwordx4 v[248:251], v5, s[36:39], s63 offen offset:3328 nt
    buffer_load_dwordx4 v[252:255], v5, s[36:39], s63 offen offset:3584 nt
    s_add_u32 s81, s81, s95
    s_sub_u32 s67, s67, 1
    s_cmp_lg_u32 s67, 0
    s_cbranch_scc1 L_ar_7
    s_mov_b32 s67, s79
    s_mov_b32 s79, 0
    s_mov_b32 s81, s80
    s_mov_b32 s95, 0xffffa000
L_ar_7:
    s_cmp_gt_i32 s67, 0
    s_cselect_b32 s63, s81, 0x80000000
    v_mov_b32 v62, 4124
    s_mov_b32 s94, 131072
L_lw_8:
    ds_read_b32 v63, v62
    s_waitcnt lgkmcnt(0)
    v_readfirstlane_b32 s87, v63
    s_nop 3
    s_cmp_ge_u32 s87, 4
    s_cbranch_scc1 L_lwd_9
    s_sub_u32 s94, s94, 1
    s_cmp_eq_u32 s94, 0
    s_cbranch_scc1 L_lwd_9
    s_sleep 1
    s_branch L_lw_8
L_lwd_9:
    s_branch L_qready
L_qphase:
    s_setprio 3
    v_lshrrev_b32 v52, 3, v2
    v_mul_u32_u24 v52, 640, v52
    v_add_lshl_u32 v52, v52, v3, 1
    s_mul_i32 s74, s57, 80
    s_mul_i32 s73, s31, 20
    s_add_u32 s74, s74, s73
    s_lshl_b32 s73, s74, 1
    v_mul_u32_u24 v53, 12288, v3
    v_lshl_add_u32 v53, v2, 4, v53
    v_add_u32 v54, 256, v53
    v_mov_b32 v55, 0x40000000
    v_cmp_gt_u32 vcc, 8, v2
    s_mul_i32 s72, s74, 12288
    s_mul_i32 s75, s56, 384
    v_cndmask_b32 v54, v55, v54, vcc
    s_add_u32 s72, s72, s75
    buffer_load_dwordx4 v[64:67], v53, s[44:47], s72 offen nt
    buffer_load_dwordx4 v[84:87], v54, s[44:47], s72 offen nt
    s_add_u32 s72, s72, 49152
    buffer_load_dwordx4 v[68:71], v53, s[44:47], s72 offen nt
    buffer_load_dwordx4 v[88:91], v54, s[44:47], s72 offen nt
    s_add_u32 s72, s72, 49152
    buffer_load_dwordx4 v[72:75], v53, s[44:47], s72 offen nt
    buffer_load_dwordx4 v[92:95], v54, s[44:47], s72 offen nt
    s_add_u32 s72, s72, 49152
    buffer_load_dwordx4 v[76:79], v53, s[44:47], s72 offen nt
    buffer_load_dwordx4 v[96:99], v54, s[44:47], s72 offen nt
    s_add_u32 s72, s72, 49152
    buffer_load_dwordx4 v[80:83], v53, s[44:47], s72 offen nt
    buffer_load_dwordx4 v[100:103], v54, s[44:47], s72 offen nt
    buffer_load_ushort v104, v52, s[48:51], s73 offen offset:0
    buffer_load_ushort v105, v52, s[48:51], s73 offen offset:2560
    buffer_load_ushort v106, v52, s[48:51], s73 offen offset:8
    buffer_load_ushort v107, v52, s[48:51], s73 offen offset:2568
    buffer_load_ushort v108, v52, s[48:51], s73 offen offset:16
    buffer_load_ushort v109, v52, s[48:51], s73 offen offset:2576
    buffer_load_ushort v110, v52, s[48:51], s73 offen offset:24
    buffer_load_ushort v111, v52, s[48:51], s73 offen offset:2584
    buffer_load_ushort v112, v52, s[48:51], s73 offen offset:32
    buffer_load_ushort v113, v52, s[48:51], s73 offen offset:2592
    s_waitcnt vmcnt(0)
    v_readfirstlane_b32 s14, v10
    v_readfirstlane_b32 s15, v11
    s_nop 3
    s_mul_i32 s14, s14, 0x9E3779B1
    s_add_u32 s14, s14, 0x632BE5AB
    s_lshr_b32 s76, s14, 15
    s_xor_b32 s15, s15, s76
    s_mul_i32 s15, s15, 0x85EBCA6B
    s_add_u32 s15, s15, 0xC2B2AE35
    v_lshl_or_b32 v104, v104, 16, v104
    v_lshl_or_b32 v105, v105, 16, v105
    v_lshl_or_b32 v106, v106, 16, v106
    v_lshl_or_b32 v107, v107, 16, v107
    v_lshl_or_b32 v108, v108, 16, v108
    v_lshl_or_b32 v109, v109, 16, v109
    v_lshl_or_b32 v110, v110, 16, v110
    v_lshl_or_b32 v111, v111, 16, v111
    v_lshl_or_b32 v112, v112, 16, v112
    v_lshl_or_b32 v113, v113, 16, v113
    v_and_b32 v44, v104, v6
    v_and_b32 v45, v104, v7
    v_and_b32 v46, v104, v8
    v_and_b32 v47, v104, v9
    v_and_b32 v48, v105, v6
    v_and_b32 v49, v105, v7
    v_and_b32 v50, v105, v8
    v_and_b32 v51, v105, v9
    s_nop 1
    v_mfma_f32_16x16x32_bf16 v[12:15], v[64:67], v[44:47], 0
    v_mfma_f32_16x16x32_bf16 v[16:19], v[64:67], v[48:51], 0
    v_mfma_f32_16x16x32_bf16 v[20:23], v[84:87], v[44:47], 0
    v_mfma_f32_16x16x32_bf16 v[24:27], v[84:87], v[48:51], 0
    v_and_b32 v44, v106, v6
    v_and_b32 v45, v106, v7
    v_and_b32 v46, v106, v8
    v_and_b32 v47, v106, v9
    v_and_b32 v48, v107, v6
    v_and_b32 v49, v107, v7
    v_and_b32 v50, v107, v8
    v_and_b32 v51, v107, v9
    s_nop 1
    v_mfma_f32_16x16x32_bf16 v[12:15], v[68:71], v[44:47], v[12:15]
    v_mfma_f32_16x16x32_bf16 v[16:19], v[68:71], v[48:51], v[16:19]
    v_mfma_f32_16x16x32_bf16 v[20:23], v[88:91], v[44:47], v[20:23]
    v_mfma_f32_16x16x32_bf16 v[24:27], v[88:91], v[48:51], v[24:27]
    v_and_b32 v44, v108, v6
    v_and_b32 v45, v108, v7
    v_and_b32 v46, v108, v8
    v_and_b32 v47, v108, v9
    v_and_b32 v48, v109, v6
    v_and_b32 v49, v109, v7
    v_and_b32 v50, v109, v8
    v_and_b32 v51, v109, v9
    s_nop 1
    v_mfma_f32_16x16x32_bf16 v[12:15], v[72:75], v[44:47], v[12:15]
    v_mfma_f32_16x16x32_bf16 v[16:19], v[72:75], v[48:51], v[16:19]
    v_mfma_f32_16x16x32_bf16 v[20:23], v[92:95], v[44:47], v[20:23]
    v_mfma_f32_16x16x32_bf16 v[24:27], v[92:95], v[48:51], v[24:27]
    v_and_b32 v44, v110, v6
    v_and_b32 v45, v110, v7
    v_and_b32 v46, v110, v8
    v_and_b32 v47, v110, v9
    v_and_b32 v48, v111, v6
    v_and_b32 v49, v111, v7
    v_and_b32 v50, v111, v8
    v_and_b32 v51, v111, v9
    s_nop 1
    v_mfma_f32_16x16x32_bf16 v[12:15], v[76:79], v[44:47], v[12:15]
    v_mfma_f32_16x16x32_bf16 v[16:19], v[76:79], v[48:51], v[16:19]
    v_mfma_f32_16x16x32_bf16 v[20:23], v[96:99], v[44:47], v[20:23]
    v_mfma_f32_16x16x32_bf16 v[24:27], v[96:99], v[48:51], v[24:27]
    v_and_b32 v44, v112, v6
    v_and_b32 v45, v112, v7
    v_and_b32 v46, v112, v8
    v_and_b32 v47, v112, v9
    v_and_b32 v48, v113, v6
    v_and_b32 v49, v113, v7
    v_and_b32 v50, v113, v8
    v_and_b32 v51, v113, v9
    s_nop 1
    v_mfma_f32_16x16x32_bf16 v[12:15], v[80:83], v[44:47], v[12:15]
    v_mfma_f32_16x16x32_bf16 v[16:19], v[80:83], v[48:51], v[16:19]
    v_mfma_f32_16x16x32_bf16 v[20:23], v[100:103], v[44:47], v[20:23]
    v_mfma_f32_16x16x32_bf16 v[24:27], v[100:103], v[48:51], v[24:27]
    s_nop 7
    s_nop 3
    s_lshl_b32 s72, s31, 12
    v_lshlrev_b32 v52, 4, v1
    v_add_u32 v52, s72, v52
    ds_write_b128 v52, v[12:15] offset:30976
    ds_write_b128 v52, v[16:19] offset:32000
    ds_write_b128 v52, v[20:23] offset:33024
    ds_write_b128 v52, v[24:27] offset:34048
    s_waitcnt lgkmcnt(0)
    v_mov_b32 v62, 4120
    v_mov_b32 v63, 1
    s_mov_b64 exec, 1
    ds_add_u32 v62, v63
    s_mov_b64 exec, -1
    v_mov_b32 v62, 4120
    s_mov_b32 s94, 131072
L_lw_10:
    ds_read_b32 v63, v62
    s_waitcnt lgkmcnt(0)
    v_readfirstlane_b32 s87, v63
    s_nop 3
    s_cmp_ge_u32 s87, 4
    s_cbranch_scc1 L_lwd_11
    s_sub_u32 s94, s94, 1
    s_cmp_eq_u32 s94, 0
    s_cbranch_scc1 L_lwd_11
    s_sleep 1
    s_branch L_lw_10
L_lwd_11:
    v_and_b32 v52, 3, v1
    v_lshlrev_b32 v52, 1, v52
    v_lshl_add_u32 v52, v3, 4, v52
    v_lshlrev_b32 v52, 4, v52
    v_bfe_u32 v61, v1, 2, 2
    v_lshl_add_u32 v52, v61, 2, v52
    s_and_b32 s72, s31, 1
    s_lshl_b32 s72, s72, 7
    s_lshr_b32 s73, s31, 1
    s_lshl_b32 s73, s73, 10
    s_add_u32 s72, s72, s73
    v_add_u32 v52, s72, v52
    ds_read_b32 v36, v52 offset:30976
    ds_read_b32 v37, v52 offset:35072
    ds_read_b32 v38, v52 offset:39168
    ds_read_b32 v39, v52 offset:43264
    ds_read_b32 v40, v52 offset:30992
    ds_read_b32 v41, v52 offset:35088
    ds_read_b32 v42, v52 offset:39184
    ds_read_b32 v43, v52 offset:43280
    ds_read_b32 v44, v52 offset:33024
    ds_read_b32 v45, v52 offset:37120
    ds_read_b32 v46, v52 offset:41216
    ds_read_b32 v47, v52 offset:45312
    ds_read_b32 v48, v52 offset:33040
    ds_read_b32 v49, v52 offset:37136
    ds_read_b32 v50, v52 offset:41232
    ds_read_b32 v51, v52 offset:45328
    s_waitcnt lgkmcnt(0)
    v_add_f32 v36, v36, v37
    v_add_f32 v38, v38, v39
    v_add_f32 v64, v36, v38
    v_add_f32 v40, v40, v41
    v_add_f32 v42, v42, v43
    v_add_f32 v65, v40, v42
    v_add_f32 v44, v44, v45
    v_add_f32 v46, v46, v47
    v_add_f32 v68, v44, v46
    v_add_f32 v48, v48, v49
    v_add_f32 v50, v50, v51
    v_add_f32 v69, v48, v50
    s_lshl_b32 s72, s56, 3
    s_add_u32 s72, s72, s57
    s_lshl_b32 s72, s72, 2
    s_add_u32 s72, s72, s31
    s_mul_i32 s72, s72, 1536
    s_add_u32 s72, s72, 2686976
    v_lshlrev_b32 v53, 4, v1
    v_mov_b32 v66, s14
    v_mov_b32 v67, s15
    buffer_store_dwordx4 v[64:67], v53, s[40:43], s72 offen offset:0 sc1
    s_mov_b32 exec_hi, 0
    v_mov_b32 v70, s14
    v_mov_b32 v71, s15
    buffer_store_dwordx4 v[68:71], v53, s[40:43], s72 offen offset:1024 sc1
    s_mov_b64 exec, -1
    s_lshr_b32 s73, s31, 1
    s_and_b32 s74, s31, 1
    s_lshl_b32 s75, s73, 1
    s_add_u32 s75, s75, s58
    s_lshl_b32 s72, s56, 5
    s_add_u32 s72, s72, s75
    s_mul_i32 s72, s72, 1536
    s_mul_i32 s75, s74, 768
    s_add_u32 s72, s72, s75
    s_add_u32 s72, s72, 2686976
    v_min_u32 v53, 47, v1
    v_lshlrev_b32 v53, 4, v53
    s_mov_b32 s94, 131072
    s_mov_b32 s76, s72
    buffer_load_dwordx4 v[72:75], v53, s[40:43], s76 offen sc1
    s_add_u32 s76, s76, 6144
    buffer_load_dwordx4 v[76:79], v53, s[40:43], s76 offen sc1
    s_add_u32 s76, s76, 6144
    buffer_load_dwordx4 v[80:83], v53, s[40:43], s76 offen sc1
    s_add_u32 s76, s76, 6144
    buffer_load_dwordx4 v[84:87], v53, s[40:43], s76 offen sc1
    s_add_u32 s76, s76, 6144
    buffer_load_dwordx4 v[88:91], v53, s[40:43], s76 offen sc1
    s_add_u32 s76, s76, 6144
    buffer_load_dwordx4 v[92:95], v53, s[40:43], s76 offen sc1
    s_add_u32 s76, s76, 6144
    buffer_load_dwordx4 v[96:99], v53, s[40:43], s76 offen sc1
    s_add_u32 s76, s76, 6144
    buffer_load_dwordx4 v[100:103], v53, s[40:43], s76 offen sc1
L_qp_12:
    s_sleep 6
    s_mov_b32 s76, s72
    buffer_load_dwordx4 v[112:115], v53, s[40:43], s76 offen sc1
    s_add_u32 s76, s76, 6144
    buffer_load_dwordx4 v[116:119], v53, s[40:43], s76 offen sc1
    s_add_u32 s76, s76, 6144
    buffer_load_dwordx4 v[120:123], v53, s[40:43], s76 offen sc1
    s_add_u32 s76, s76, 6144
    buffer_load_dwordx4 v[124:127], v53, s[40:43], s76 offen sc1
    s_add_u32 s76, s76, 6144
    buffer_load_dwordx4 v[128:131], v53, s[40:43], s76 offen sc1
    s_add_u32 s76, s76, 6144
    buffer_load_dwordx4 v[132:135], v53, s[40:43], s76 offen sc1
    s_add_u32 s76, s76, 6144
    buffer_load_dwordx4 v[136:139], v53, s[40:43], s76 offen sc1
    s_add_u32 s76, s76, 6144
    buffer_load_dwordx4 v[140:143], v53, s[40:43], s76 offen sc1
    s_waitcnt vmcnt(8)
    v_xor_b32 v55, s14, v74
    v_xor_b32 v54, s15, v75
    v_or_b32 v54, v54, v55
    v_xor_b32 v55, s14, v78
    v_xor_b32 v56, s15, v79
    v_or3_b32 v54, v54, v55, v56
    v_xor_b32 v55, s14, v82
    v_xor_b32 v56, s15, v83
    v_or3_b32 v54, v54, v55, v56
    v_xor_b32 v55, s14, v86
    v_xor_b32 v56, s15, v87
    v_or3_b32 v54, v54, v55, v56
    v_xor_b32 v55, s14, v90
    v_xor_b32 v56, s15, v91
    v_or3_b32 v54, v54, v55, v56
    v_xor_b32 v55, s14, v94
    v_xor_b32 v56, s15, v95
    v_or3_b32 v54, v54, v55, v56
    v_xor_b32 v55, s14, v98
    v_xor_b32 v56, s15, v99
    v_or3_b32 v54, v54, v55, v56
    v_xor_b32 v55, s14, v102
    v_xor_b32 v56, s15, v103
    v_or3_b32 v54, v54, v55, v56
    v_cmp_ne_u32 vcc, 0, v54
    s_cbranch_vccz L_qpd_13
    s_sub_u32 s94, s94, 1
    s_cmp_eq_u32 s94, 0
    s_cbranch_scc1 L_qpd_13
    s_sleep 6
    s_mov_b32 s76, s72
    buffer_load_dwordx4 v[72:75], v53, s[40:43], s76 offen sc1
    s_add_u32 s76, s76, 6144
    buffer_load_dwordx4 v[76:79], v53, s[40:43], s76 offen sc1
    s_add_u32 s76, s76, 6144
    buffer_load_dwordx4 v[80:83], v53, s[40:43], s76 offen sc1
    s_add_u32 s76, s76, 6144
    buffer_load_dwordx4 v[84:87], v53, s[40:43], s76 offen sc1
    s_add_u32 s76, s76, 6144
    buffer_load_dwordx4 v[88:91], v53, s[40:43], s76 offen sc1
    s_add_u32 s76, s76, 6144
    buffer_load_dwordx4 v[92:95], v53, s[40:43], s76 offen sc1
    s_add_u32 s76, s76, 6144
    buffer_load_dwordx4 v[96:99], v53, s[40:43], s76 offen sc1
    s_add_u32 s76, s76, 6144
    buffer_load_dwordx4 v[100:103], v53, s[40:43], s76 offen sc1
    s_waitcnt vmcnt(8)
    v_xor_b32 v55, s14, v114
    v_xor_b32 v54, s15, v115
    v_or_b32 v54, v54, v55
    v_xor_b32 v55, s14, v118
    v_xor_b32 v56, s15, v119
    v_or3_b32 v54, v54, v55, v56
    v_xor_b32 v55, s14, v122
    v_xor_b32 v56, s15, v123
    v_or3_b32 v54, v54, v55, v56
    v_xor_b32 v55, s14, v126
    v_xor_b32 v56, s15, v127
    v_or3_b32 v54, v54, v55, v56
    v_xor_b32 v55, s14, v130
    v_xor_b32 v56, s15, v131
    v_or3_b32 v54, v54, v55, v56
    v_xor_b32 v55, s14, v134
    v_xor_b32 v56, s15, v135
    v_or3_b32 v54, v54, v55, v56
    v_xor_b32 v55, s14, v138
    v_xor_b32 v56, s15, v139
    v_or3_b32 v54, v54, v55, v56
    v_xor_b32 v55, s14, v142
    v_xor_b32 v56, s15, v143
    v_or3_b32 v54, v54, v55, v56
    v_cmp_ne_u32 vcc, 0, v54
    s_cbranch_vccnz L_qp_12
    s_waitcnt vmcnt(0)
    v_mov_b32 v72, v112
    v_mov_b32 v73, v113
    v_mov_b32 v76, v116
    v_mov_b32 v77, v117
    v_mov_b32 v80, v120
    v_mov_b32 v81, v121
    v_mov_b32 v84, v124
    v_mov_b32 v85, v125
    v_mov_b32 v88, v128
    v_mov_b32 v89, v129
    v_mov_b32 v92, v132
    v_mov_b32 v93, v133
    v_mov_b32 v96, v136
    v_mov_b32 v97, v137
    v_mov_b32 v100, v140
    v_mov_b32 v101, v141
L_qpd_13:
    v_add_f32 v72, v72, v76
    v_add_f32 v73, v73, v77
    v_add_f32 v72, v72, v80
    v_add_f32 v73, v73, v81
    v_add_f32 v72, v72, v84
    v_add_f32 v73, v73, v85
    v_add_f32 v72, v72, v88
    v_add_f32 v73, v73, v89
    v_add_f32 v72, v72, v92
    v_add_f32 v73, v73, v93
    v_add_f32 v72, v72, v96
    v_add_f32 v73, v73, v97
    v_add_f32 v72, v72, v100
    v_add_f32 v73, v73, v101
    v_cvt_pk_bf16_f32 v72, v72, v73
    s_mul_i32 s73, s73, 384
    s_mul_i32 s74, s74, 192
    s_add_u32 s73, s73, s74
    v_min_u32 v53, 47, v1
    v_lshlrev_b32 v53, 2, v53
    v_add_u32 v53, s73, v53
    ds_write_b32 v53, v72 offset:0
    s_waitcnt lgkmcnt(0)
    v_mov_b32 v62, 4124
    v_mov_b32 v63, 1
    s_mov_b64 exec, 1
    ds_add_u32 v62, v63
    s_mov_b64 exec, -1
    v_mov_b32 v62, 4124
    s_mov_b32 s94, 131072
L_lw_15:
    ds_read_b32 v63, v62
    s_waitcnt lgkmcnt(0)
    v_readfirstlane_b32 s87, v63
    s_nop 3
    s_cmp_ge_u32 s87, 4
    s_cbranch_scc1 L_lwd_16
    s_sub_u32 s94, s94, 1
    s_cmp_eq_u32 s94, 0
    s_cbranch_scc1 L_lwd_16
    s_sleep 1
    s_branch L_lw_15
L_lwd_16:
    s_setprio 0
    s_waitcnt vmcnt(0)
    buffer_load_dwordx4 v[64:67], v4, s[32:35], s63 offen offset:0 nt
    buffer_load_dwordx4 v[68:71], v4, s[32:35], s63 offen offset:256 nt
    buffer_load_dwordx4 v[72:75], v4, s[32:35], s63 offen offset:512 nt
    buffer_load_dwordx4 v[76:79], v4, s[32:35], s63 offen offset:3072 nt
    buffer_load_dwordx4 v[80:83], v4, s[32:35], s63 offen offset:3328 nt
    buffer_load_dwordx4 v[84:87], v4, s[32:35], s63 offen offset:3584 nt
    buffer_load_dwordx4 v[88:91], v5, s[36:39], s63 offen offset:0 nt
    buffer_load_dwordx4 v[92:95], v5, s[36:39], s63 offen offset:256 nt
    buffer_load_dwordx4 v[96:99], v5, s[36:39], s63 offen offset:512 nt
    buffer_load_dwordx4 v[100:103], v5, s[36:39], s63 offen offset:3072 nt
    buffer_load_dwordx4 v[104:107], v5, s[36:39], s63 offen offset:3328 nt
    buffer_load_dwordx4 v[108:111], v5, s[36:39], s63 offen offset:3584 nt
    s_add_u32 s81, s81, s95
    s_sub_u32 s67, s67, 1
    s_cmp_gt_i32 s67, 0
    s_cselect_b32 s63, s81, 0x80000000
    buffer_load_dwordx4 v[112:115], v4, s[32:35], s63 offen offset:0 nt
    buffer_load_dwordx4 v[116:119], v4, s[32:35], s63 offen offset:256 nt
    buffer_load_dwordx4 v[120:123], v4, s[32:35], s63 offen offset:512 nt
    buffer_load_dwordx4 v[124:127], v4, s[32:35], s63 offen offset:3072 nt
    buffer_load_dwordx4 v[128:131], v4, s[32:35], s63 offen offset:3328 nt
    buffer_load_dwordx4 v[132:135], v4, s[32:35], s63 offen offset:3584 nt
    buffer_load_dwordx4 v[136:139], v5, s[36:39], s63 offen offset:0 nt
    buffer_load_dwordx4 v[140:143], v5, s[36:39], s63 offen offset:256 nt
    buffer_load_dwordx4 v[144:147], v5, s[36:39], s63 offen offset:512 nt
    buffer_load_dwordx4 v[148:151], v5, s[36:39], s63 offen offset:3072 nt
    buffer_load_dwordx4 v[152:155], v5, s[36:39], s63 offen offset:3328 nt
    buffer_load_dwordx4 v[156:159], v5, s[36:39], s63 offen offset:3584 nt
    s_add_u32 s81, s81, s95
    s_sub_u32 s67, s67, 1
    s_cmp_gt_i32 s67, 0
    s_cselect_b32 s63, s81, 0x80000000
    buffer_load_dwordx4 v[160:163], v4, s[32:35], s63 offen offset:0 nt
    buffer_load_dwordx4 v[164:167], v4, s[32:35], s63 offen offset:256 nt
    buffer_load_dwordx4 v[168:171], v4, s[32:35], s63 offen offset:512 nt
    buffer_load_dwordx4 v[172:175], v4, s[32:35], s63 offen offset:3072 nt
    buffer_load_dwordx4 v[176:179], v4, s[32:35], s63 offen offset:3328 nt
    buffer_load_dwordx4 v[180:183], v4, s[32:35], s63 offen offset:3584 nt
    buffer_load_dwordx4 v[184:187], v5, s[36:39], s63 offen offset:0 nt
    buffer_load_dwordx4 v[188:191], v5, s[36:39], s63 offen offset:256 nt
    buffer_load_dwordx4 v[192:195], v5, s[36:39], s63 offen offset:512 nt
    buffer_load_dwordx4 v[196:199], v5, s[36:39], s63 offen offset:3072 nt
    buffer_load_dwordx4 v[200:203], v5, s[36:39], s63 offen offset:3328 nt
    buffer_load_dwordx4 v[204:207], v5, s[36:39], s63 offen offset:3584 nt
    s_add_u32 s81, s81, s95
    s_sub_u32 s67, s67, 1
    s_cmp_gt_i32 s67, 0
    s_cselect_b32 s63, s81, 0x80000000
    buffer_load_dwordx4 v[208:211], v4, s[32:35], s63 offen offset:0 nt
    buffer_load_dwordx4 v[212:215], v4, s[32:35], s63 offen offset:256 nt
    buffer_load_dwordx4 v[216:219], v4, s[32:35], s63 offen offset:512 nt
    buffer_load_dwordx4 v[220:223], v4, s[32:35], s63 offen offset:3072 nt
    buffer_load_dwordx4 v[224:227], v4, s[32:35], s63 offen offset:3328 nt
    buffer_load_dwordx4 v[228:231], v4, s[32:35], s63 offen offset:3584 nt
    buffer_load_dwordx4 v[232:235], v5, s[36:39], s63 offen offset:0 nt
    buffer_load_dwordx4 v[236:239], v5, s[36:39], s63 offen offset:256 nt
    buffer_load_dwordx4 v[240:243], v5, s[36:39], s63 offen offset:512 nt
    buffer_load_dwordx4 v[244:247], v5, s[36:39], s63 offen offset:3072 nt
    buffer_load_dwordx4 v[248:251], v5, s[36:39], s63 offen offset:3328 nt
    buffer_load_dwordx4 v[252:255], v5, s[36:39], s63 offen offset:3584 nt
    s_add_u32 s81, s81, s95
    s_sub_u32 s67, s67, 1
    s_cmp_gt_i32 s67, 0
    s_cselect_b32 s63, s81, 0x80000000
    s_branch L_qready2
L_qready:
    s_waitcnt vmcnt(48)
    v_readfirstlane_b32 s14, v10
    v_readfirstlane_b32 s15, v11
    s_nop 3
    s_mul_i32 s14, s14, 0x9E3779B1
    s_add_u32 s14, s14, 0x632BE5AB
    s_lshr_b32 s76, s14, 15
    s_xor_b32 s15, s15, s76
    s_mul_i32 s15, s15, 0x85EBCA6B
    s_add_u32 s15, s15, 0xC2B2AE35
L_qready2:
    v_and_b32 v52, 3, v2
    v_lshl_add_u32 v52, v3, 2, v52
    v_lshlrev_b32 v52, 4, v52
    s_mul_i32 s72, s60, 384
    s_add_u32 s72, s72, 0
    v_add_u32 v52, s72, v52
    v_mov_b32 v53, 768
    v_cmp_gt_u32 s[74:75], 8, v2
    v_cmp_gt_u32 s[76:77], 2, v3
    s_nop 1
    v_cndmask_b32 v54, v53, v52, s[74:75]
    v_add_u32 v55, 128, v52
    v_cndmask_b32 v56, v55, v53, s[74:75]
    v_add_u32 v55, 256, v52
    v_cndmask_b32 v55, v53, v55, s[76:77]
    v_subrev_u32 v57, 128, v52
    v_cndmask_b32 v57, v57, v53, s[76:77]
    v_cndmask_b32 v55, v57, v55, s[74:75]
    ds_read_b128 v[24:27], v54
    ds_read_b128 v[28:31], v55
    ds_read_b128 v[32:35], v56
    v_mov_b32 v12, 0
    v_mov_b32 v13, 0
    v_mov_b32 v14, 0
    v_mov_b32 v15, 0
    v_mov_b32 v16, 0
    v_mov_b32 v17, 0
    v_mov_b32 v18, 0
    v_mov_b32 v19, 0
    v_mov_b32 v20, 0
    v_mov_b32 v21, 0
    v_mov_b32 v22, 0
    v_mov_b32 v23, 0
    v_mov_b32 v10, 0
    v_mov_b32 v11, 0xff800000
    s_mov_b32 s64, 0
    v_mov_b32 v62, 0
    s_waitcnt lgkmcnt(0)
    s_cmp_eq_u32 s60, 0
    s_cbranch_scc0 L_main_1
L_main_0:
    s_cmp_ge_u32 s84, s85
    s_cbranch_scc1 L_fin
    s_add_u32 s84, s84, 1
    s_waitcnt vmcnt(42)
    v_mfma_f32_16x16x32_bf16 v[36:39], v[64:67], v[24:27], 0
    v_mfma_f32_16x16x32_bf16 v[40:43], v[76:79], v[24:27], 0
    v_mfma_f32_16x16x32_bf16 v[36:39], v[68:71], v[28:31], v[36:39]
    v_mfma_f32_16x16x32_bf16 v[40:43], v[80:83], v[28:31], v[40:43]
    v_mfma_f32_16x16x32_bf16 v[36:39], v[72:75], v[32:35], v[36:39]
    v_mfma_f32_16x16x32_bf16 v[40:43], v[84:87], v[32:35], v[40:43]
    buffer_load_dwordx4 v[64:67], v4, s[32:35], s63 offen offset:0 nt
    buffer_load_dwordx4 v[68:71], v4, s[32:35], s63 offen offset:256 nt
    buffer_load_dwordx4 v[72:75], v4, s[32:35], s63 offen offset:512 nt
    buffer_load_dwordx4 v[76:79], v4, s[32:35], s63 offen offset:3072 nt
    buffer_load_dwordx4 v[80:83], v4, s[32:35], s63 offen offset:3328 nt
    buffer_load_dwordx4 v[84:87], v4, s[32:35], s63 offen offset:3584 nt
    s_nop 1
    v_cndmask_b32 v52, v36, v37, s[68:69]
    v_cndmask_b32 v54, v38, v39, s[68:69]
    v_cndmask_b32 v53, v40, v41, s[68:69]
    v_cndmask_b32 v55, v42, v43, s[68:69]
    v_cndmask_b32 v52, v52, v54, s[70:71]
    v_cndmask_b32 v53, v53, v55, s[70:71]
    s_nop 0
    v_add_f32_dpp v52, v52, v52 quad_perm:[1,0,3,2] row_mask:0xf bank_mask:0xf
    v_add_f32_dpp v53, v53, v53 quad_perm:[1,0,3,2] row_mask:0xf bank_mask:0xf
    s_nop 0
    v_add_f32_dpp v52, v52, v52 quad_perm:[2,3,0,1] row_mask:0xf bank_mask:0xf
    v_add_f32_dpp v53, v53, v53 quad_perm:[2,3,0,1] row_mask:0xf bank_mask:0xf
    v_fma_f32 v56, v52, s65, -v11
    v_fma_f32 v57, v53, s65, -v11
    v_max_f32 v58, v56, v57
    v_cmp_lt_f32 vcc, s66, v58
    s_cbranch_vccnz L_resc_0_0
L_back_0_0:
    v_exp_f32 v56, v56
    v_exp_f32 v57, v57
    s_nop 0
    v_cvt_pk_bf16_f32 v52, v56, v56
    v_cvt_pk_bf16_f32 v53, v57, v57
    v_add_f32 v10, v10, v56
    v_add_f32 v10, v10, v57
    v_and_b32 v44, v52, v6
    v_and_b32 v45, v52, v7
    v_and_b32 v46, v52, v8
    v_and_b32 v47, v52, v9
    v_and_b32 v48, v53, v6
    v_and_b32 v49, v53, v7
    v_and_b32 v50, v53, v8
    v_and_b32 v51, v53, v9
    s_waitcnt vmcnt(42)
    v_mfma_f32_16x16x32_bf16 v[12:15], v[88:91], v[44:47], v[12:15]
    v_mfma_f32_16x16x32_bf16 v[16:19], v[92:95], v[44:47], v[16:19]
    v_mfma_f32_16x16x32_bf16 v[20:23], v[96:99], v[44:47], v[20:23]
    v_mfma_f32_16x16x32_bf16 v[12:15], v[100:103], v[48:51], v[12:15]
    v_mfma_f32_16x16x32_bf16 v[16:19], v[104:107], v[48:51], v[16:19]
    v_mfma_f32_16x16x32_bf16 v[20:23], v[108:111], v[48:51], v[20:23]
    buffer_load_dwordx4 v[88:91], v5, s[36:39], s63 offen offset:0 nt
    buffer_load_dwordx4 v[92:95], v5, s[36:39], s63 offen offset:256 nt
    buffer_load_dwordx4 v[96:99], v5, s[36:39], s63 offen offset:512 nt
    buffer_load_dwordx4 v[100:103], v5, s[36:39], s63 offen offset:3072 nt
    buffer_load_dwordx4 v[104:107], v5, s[36:39], s63 offen offset:3328 nt
    buffer_load_dwordx4 v[108:111], v5, s[36:39], s63 offen offset:3584 nt
    s_add_u32 s81, s81, s95
    s_sub_u32 s67, s67, 1
    s_cmp_gt_i32 s67, 0
    s_cselect_b32 s63, s81, 0x80000000
    s_cmp_ge_u32 s84, s85
    s_cbranch_scc1 L_fin
    s_add_u32 s84, s84, 1
    s_waitcnt vmcnt(42)
    v_mfma_f32_16x16x32_bf16 v[36:39], v[112:115], v[24:27], 0
    v_mfma_f32_16x16x32_bf16 v[40:43], v[124:127], v[24:27], 0
    v_mfma_f32_16x16x32_bf16 v[36:39], v[116:119], v[28:31], v[36:39]
    v_mfma_f32_16x16x32_bf16 v[40:43], v[128:131], v[28:31], v[40:43]
    v_mfma_f32_16x16x32_bf16 v[36:39], v[120:123], v[32:35], v[36:39]
    v_mfma_f32_16x16x32_bf16 v[40:43], v[132:135], v[32:35], v[40:43]
    buffer_load_dwordx4 v[112:115], v4, s[32:35], s63 offen offset:0 nt
    buffer_load_dwordx4 v[116:119], v4, s[32:35], s63 offen offset:256 nt
    buffer_load_dwordx4 v[120:123], v4, s[32:35], s63 offen offset:512 nt
    buffer_load_dwordx4 v[124:127], v4, s[32:35], s63 offen offset:3072 nt
    buffer_load_dwordx4 v[128:131], v4, s[32:35], s63 offen offset:3328 nt
    buffer_load_dwordx4 v[132:135], v4, s[32:35], s63 offen offset:3584 nt
    s_nop 1
    v_cndmask_b32 v52, v36, v37, s[68:69]
    v_cndmask_b32 v54, v38, v39, s[68:69]
    v_cndmask_b32 v53, v40, v41, s[68:69]
    v_cndmask_b32 v55, v42, v43, s[68:69]
    v_cndmask_b32 v52, v52, v54, s[70:71]
    v_cndmask_b32 v53, v53, v55, s[70:71]
    s_nop 0
    v_add_f32_dpp v52, v52, v52 quad_perm:[1,0,3,2] row_mask:0xf bank_mask:0xf
    v_add_f32_dpp v53, v53, v53 quad_perm:[1,0,3,2] row_mask:0xf bank_mask:0xf
    s_nop 0
    v_add_f32_dpp v52, v52, v52 quad_perm:[2,3,0,1] row_mask:0xf bank_mask:0xf
    v_add_f32_dpp v53, v53, v53 quad_perm:[2,3,0,1] row_mask:0xf bank_mask:0xf
    v_fma_f32 v56, v52, s65, -v11
    v_fma_f32 v57, v53, s65, -v11
    v_max_f32 v58, v56, v57
    v_cmp_lt_f32 vcc, s66, v58
    s_cbranch_vccnz L_resc_0_1
L_back_0_1:
    v_exp_f32 v56, v56
    v_exp_f32 v57, v57
    s_nop 0
    v_cvt_pk_bf16_f32 v52, v56, v56
    v_cvt_pk_bf16_f32 v53, v57, v57
    v_add_f32 v10, v10, v56
    v_add_f32 v10, v10, v57
    v_and_b32 v44, v52, v6
    v_and_b32 v45, v52, v7
    v_and_b32 v46, v52, v8
    v_and_b32 v47, v52, v9
    v_and_b32 v48, v53, v6
    v_and_b32 v49, v53, v7
    v_and_b32 v50, v53, v8
    v_and_b32 v51, v53, v9
    s_waitcnt vmcnt(42)
    v_mfma_f32_16x16x32_bf16 v[12:15], v[136:139], v[44:47], v[12:15]
    v_mfma_f32_16x16x32_bf16 v[16:19], v[140:143], v[44:47], v[16:19]
    v_mfma_f32_16x16x32_bf16 v[20:23], v[144:147], v[44:47], v[20:23]
    v_mfma_f32_16x16x32_bf16 v[12:15], v[148:151], v[48:51], v[12:15]
    v_mfma_f32_16x16x32_bf16 v[16:19], v[152:155], v[48:51], v[16:19]
    v_mfma_f32_16x16x32_bf16 v[20:23], v[156:159], v[48:51], v[20:23]
    buffer_load_dwordx4 v[136:139], v5, s[36:39], s63 offen offset:0 nt
    buffer_load_dwordx4 v[140:143], v5, s[36:39], s63 offen offset:256 nt
    buffer_load_dwordx4 v[144:147], v5, s[36:39], s63 offen offset:512 nt
    buffer_load_dwordx4 v[148:151], v5, s[36:39], s63 offen offset:3072 nt
    buffer_load_dwordx4 v[152:155], v5, s[36:39], s63 offen offset:3328 nt
    buffer_load_dwordx4 v[156:159], v5, s[36:39], s63 offen offset:3584 nt
    s_add_u32 s81, s81, s95
    s_sub_u32 s67, s67, 1
    s_cmp_gt_i32 s67, 0
    s_cselect_b32 s63, s81, 0x80000000
    s_cmp_ge_u32 s84, s85
    s_cbranch_scc1 L_fin
    s_add_u32 s84, s84, 1
    s_waitcnt vmcnt(42)
    v_mfma_f32_16x16x32_bf16 v[36:39], v[160:163], v[24:27], 0
    v_mfma_f32_16x16x32_bf16 v[40:43], v[172:175], v[24:27], 0
    v_mfma_f32_16x16x32_bf16 v[36:39], v[164:167], v[28:31], v[36:39]
    v_mfma_f32_16x16x32_bf16 v[40:43], v[176:179], v[28:31], v[40:43]
    v_mfma_f32_16x16x32_bf16 v[36:39], v[168:171], v[32:35], v[36:39]
    v_mfma_f32_16x16x32_bf16 v[40:43], v[180:183], v[32:35], v[40:43]
    buffer_load_dwordx4 v[160:163], v4, s[32:35], s63 offen offset:0 nt
    buffer_load_dwordx4 v[164:167], v4, s[32:35], s63 offen offset:256 nt
    buffer_load_dwordx4 v[168:171], v4, s[32:35], s63 offen offset:512 nt
    buffer_load_dwordx4 v[172:175], v4, s[32:35], s63 offen offset:3072 nt
    buffer_load_dwordx4 v[176:179], v4, s[32:35], s63 offen offset:3328 nt
    buffer_load_dwordx4 v[180:183], v4, s[32:35], s63 offen offset:3584 nt
    s_nop 1
    v_cndmask_b32 v52, v36, v37, s[68:69]
    v_cndmask_b32 v54, v38, v39, s[68:69]
    v_cndmask_b32 v53, v40, v41, s[68:69]
    v_cndmask_b32 v55, v42, v43, s[68:69]
    v_cndmask_b32 v52, v52, v54, s[70:71]
    v_cndmask_b32 v53, v53, v55, s[70:71]
    s_nop 0
    v_add_f32_dpp v52, v52, v52 quad_perm:[1,0,3,2] row_mask:0xf bank_mask:0xf
    v_add_f32_dpp v53, v53, v53 quad_perm:[1,0,3,2] row_mask:0xf bank_mask:0xf
    s_nop 0
    v_add_f32_dpp v52, v52, v52 quad_perm:[2,3,0,1] row_mask:0xf bank_mask:0xf
    v_add_f32_dpp v53, v53, v53 quad_perm:[2,3,0,1] row_mask:0xf bank_mask:0xf
    v_fma_f32 v56, v52, s65, -v11
    v_fma_f32 v57, v53, s65, -v11
    v_max_f32 v58, v56, v57
    v_cmp_lt_f32 vcc, s66, v58
    s_cbranch_vccnz L_resc_0_2
L_back_0_2:
    v_exp_f32 v56, v56
    v_exp_f32 v57, v57
    s_nop 0
    v_cvt_pk_bf16_f32 v52, v56, v56
    v_cvt_pk_bf16_f32 v53, v57, v57
    v_add_f32 v10, v10, v56
    v_add_f32 v10, v10, v57
    v_and_b32 v44, v52, v6
    v_and_b32 v45, v52, v7
    v_and_b32 v46, v52, v8
    v_and_b32 v47, v52, v9
    v_and_b32 v48, v53, v6
    v_and_b32 v49, v53, v7
    v_and_b32 v50, v53, v8
    v_and_b32 v51, v53, v9
    s_waitcnt vmcnt(42)
    v_mfma_f32_16x16x32_bf16 v[12:15], v[184:187], v[44:47], v[12:15]
    v_mfma_f32_16x16x32_bf16 v[16:19], v[188:191], v[44:47], v[16:19]
    v_mfma_f32_16x16x32_bf16 v[20:23], v[192:195], v[44:47], v[20:23]
    v_mfma_f32_16x16x32_bf16 v[12:15], v[196:199], v[48:51], v[12:15]
    v_mfma_f32_16x16x32_bf16 v[16:19], v[200:203], v[48:51], v[16:19]
    v_mfma_f32_16x16x32_bf16 v[20:23], v[204:207], v[48:51], v[20:23]
    buffer_load_dwordx4 v[184:187], v5, s[36:39], s63 offen offset:0 nt
    buffer_load_dwordx4 v[188:191], v5, s[36:39], s63 offen offset:256 nt
    buffer_load_dwordx4 v[192:195], v5, s[36:39], s63 offen offset:512 nt
    buffer_load_dwordx4 v[196:199], v5, s[36:39], s63 offen offset:3072 nt
    buffer_load_dwordx4 v[200:203], v5, s[36:39], s63 offen offset:3328 nt
    buffer_load_dwordx4 v[204:207], v5, s[36:39], s63 offen offset:3584 nt
    s_add_u32 s81, s81, s95
    s_sub_u32 s67, s67, 1
    s_cmp_gt_i32 s67, 0
    s_cselect_b32 s63, s81, 0x80000000
    s_cmp_ge_u32 s84, s85
    s_cbranch_scc1 L_fin
    s_add_u32 s84, s84, 1
    s_waitcnt vmcnt(42)
    v_mfma_f32_16x16x32_bf16 v[36:39], v[208:211], v[24:27], 0
    v_mfma_f32_16x16x32_bf16 v[40:43], v[220:223], v[24:27], 0
    v_mfma_f32_16x16x32_bf16 v[36:39], v[212:215], v[28:31], v[36:39]
    v_mfma_f32_16x16x32_bf16 v[40:43], v[224:227], v[28:31], v[40:43]
    v_mfma_f32_16x16x32_bf16 v[36:39], v[216:219], v[32:35], v[36:39]
    v_mfma_f32_16x16x32_bf16 v[40:43], v[228:231], v[32:35], v[40:43]
    buffer_load_dwordx4 v[208:211], v4, s[32:35], s63 offen offset:0 nt
    buffer_load_dwordx4 v[212:215], v4, s[32:35], s63 offen offset:256 nt
    buffer_load_dwordx4 v[216:219], v4, s[32:35], s63 offen offset:512 nt
    buffer_load_dwordx4 v[220:223], v4, s[32:35], s63 offen offset:3072 nt
    buffer_load_dwordx4 v[224:227], v4, s[32:35], s63 offen offset:3328 nt
    buffer_load_dwordx4 v[228:231], v4, s[32:35], s63 offen offset:3584 nt
    s_nop 1
    v_cndmask_b32 v52, v36, v37, s[68:69]
    v_cndmask_b32 v54, v38, v39, s[68:69]
    v_cndmask_b32 v53, v40, v41, s[68:69]
    v_cndmask_b32 v55, v42, v43, s[68:69]
    v_cndmask_b32 v52, v52, v54, s[70:71]
    v_cndmask_b32 v53, v53, v55, s[70:71]
    s_nop 0
    v_add_f32_dpp v52, v52, v52 quad_perm:[1,0,3,2] row_mask:0xf bank_mask:0xf
    v_add_f32_dpp v53, v53, v53 quad_perm:[1,0,3,2] row_mask:0xf bank_mask:0xf
    s_nop 0
    v_add_f32_dpp v52, v52, v52 quad_perm:[2,3,0,1] row_mask:0xf bank_mask:0xf
    v_add_f32_dpp v53, v53, v53 quad_perm:[2,3,0,1] row_mask:0xf bank_mask:0xf
    v_fma_f32 v56, v52, s65, -v11
    v_fma_f32 v57, v53, s65, -v11
    v_max_f32 v58, v56, v57
    v_cmp_lt_f32 vcc, s66, v58
    s_cbranch_vccnz L_resc_0_3
L_back_0_3:
    v_exp_f32 v56, v56
    v_exp_f32 v57, v57
    s_nop 0
    v_cvt_pk_bf16_f32 v52, v56, v56
    v_cvt_pk_bf16_f32 v53, v57, v57
    v_add_f32 v10, v10, v56
    v_add_f32 v10, v10, v57
    v_and_b32 v44, v52, v6
    v_and_b32 v45, v52, v7
    v_and_b32 v46, v52, v8
    v_and_b32 v47, v52, v9
    v_and_b32 v48, v53, v6
    v_and_b32 v49, v53, v7
    v_and_b32 v50, v53, v8
    v_and_b32 v51, v53, v9
    s_waitcnt vmcnt(42)
    v_mfma_f32_16x16x32_bf16 v[12:15], v[232:235], v[44:47], v[12:15]
    v_mfma_f32_16x16x32_bf16 v[16:19], v[236:239], v[44:47], v[16:19]
    v_mfma_f32_16x16x32_bf16 v[20:23], v[240:243], v[44:47], v[20:23]
    v_mfma_f32_16x16x32_bf16 v[12:15], v[244:247], v[48:51], v[12:15]
    v_mfma_f32_16x16x32_bf16 v[16:19], v[248:251], v[48:51], v[16:19]
    v_mfma_f32_16x16x32_bf16 v[20:23], v[252:255], v[48:51], v[20:23]
    buffer_load_dwordx4 v[232:235], v5, s[36:39], s63 offen offset:0 nt
    buffer_load_dwordx4 v[236:239], v5, s[36:39], s63 offen offset:256 nt
    buffer_load_dwordx4 v[240:243], v5, s[36:39], s63 offen offset:512 nt
    buffer_load_dwordx4 v[244:247], v5, s[36:39], s63 offen offset:3072 nt
    buffer_load_dwordx4 v[248:251], v5, s[36:39], s63 offen offset:3328 nt
    buffer_load_dwordx4 v[252:255], v5, s[36:39], s63 offen offset:3584 nt
    s_add_u32 s81, s81, s95
    s_sub_u32 s67, s67, 1
    s_cmp_gt_i32 s67, 0
    s_cselect_b32 s63, s81, 0x80000000
    s_branch L_main_0
L_resc_0_0:
    v_mul_f32 v52, s65, v52
    v_mul_f32 v53, s65, v53
    v_max_f32 v58, v52, v53
    s_nop 1
    v_max_f32_dpp v58, v58, v58 row_ror:8 row_mask:0xf bank_mask:0xf
    s_nop 1
    v_readlane_b32 s72, v58, 0
    v_readlane_b32 s73, v58, 16
    v_readlane_b32 s74, v58, 32
    v_readlane_b32 s75, v58, 48
    s_nop 3
    v_max_f32 v58, s72, v11
    v_max_f32 v58, s73, v58
    v_max_f32 v58, s74, v58
    v_max_f32 v58, s75, v58
    v_sub_f32 v54, v11, v58
    v_exp_f32 v54, v54
    v_mov_b32 v11, v58
    s_nop 7
    v_mul_f32 v12, v12, v54
    v_mul_f32 v13, v13, v54
    v_mul_f32 v14, v14, v54
    v_mul_f32 v15, v15, v54
    v_mul_f32 v16, v16, v54
    v_mul_f32 v17, v17, v54
    v_mul_f32 v18, v18, v54
    v_mul_f32 v19, v19, v54
    v_mul_f32 v20, v20, v54
    v_mul_f32 v21, v21, v54
    v_mul_f32 v22, v22, v54
    v_mul_f32 v23, v23, v54
    v_mul_f32 v10, v10, v54
    v_sub_f32 v56, v52, v11
    v_sub_f32 v57, v53, v11
    s_branch L_back_0_0
L_resc_0_1:
    v_mul_f32 v52, s65, v52
    v_mul_f32 v53, s65, v53
    v_max_f32 v58, v52, v53
    s_nop 1
    v_max_f32_dpp v58, v58, v58 row_ror:8 row_mask:0xf bank_mask:0xf
    s_nop 1
    v_readlane_b32 s72, v58, 0
    v_readlane_b32 s73, v58, 16
    v_readlane_b32 s74, v58, 32
    v_readlane_b32 s75, v58, 48
    s_nop 3
    v_max_f32 v58, s72, v11
    v_max_f32 v58, s73, v58
    v_max_f32 v58, s74, v58
    v_max_f32 v58, s75, v58
    v_sub_f32 v54, v11, v58
    v_exp_f32 v54, v54
    v_mov_b32 v11, v58
    s_nop 7
    v_mul_f32 v12, v12, v54
    v_mul_f32 v13, v13, v54
    v_mul_f32 v14, v14, v54
    v_mul_f32 v15, v15, v54
    v_mul_f32 v16, v16, v54
    v_mul_f32 v17, v17, v54
    v_mul_f32 v18, v18, v54
    v_mul_f32 v19, v19, v54
    v_mul_f32 v20, v20, v54
    v_mul_f32 v21, v21, v54
    v_mul_f32 v22, v22, v54
    v_mul_f32 v23, v23, v54
    v_mul_f32 v10, v10, v54
    v_sub_f32 v56, v52, v11
    v_sub_f32 v57, v53, v11
    s_branch L_back_0_1
L_resc_0_2:
    v_mul_f32 v52, s65, v52
    v_mul_f32 v53, s65, v53
    v_max_f32 v58, v52, v53
    s_nop 1
    v_max_f32_dpp v58, v58, v58 row_ror:8 row_mask:0xf bank_mask:0xf
    s_nop 1
    v_readlane_b32 s72, v58, 0
    v_readlane_b32 s73, v58, 16
    v_readlane_b32 s74, v58, 32
    v_readlane_b32 s75, v58, 48
    s_nop 3
    v_max_f32 v58, s72, v11
    v_max_f32 v58, s73, v58
    v_max_f32 v58, s74, v58
    v_max_f32 v58, s75, v58
    v_sub_f32 v54, v11, v58
    v_exp_f32 v54, v54
    v_mov_b32 v11, v58
    s_nop 7
    v_mul_f32 v12, v12, v54
    v_mul_f32 v13, v13, v54
    v_mul_f32 v14, v14, v54
    v_mul_f32 v15, v15, v54
    v_mul_f32 v16, v16, v54
    v_mul_f32 v17, v17, v54
    v_mul_f32 v18, v18, v54
    v_mul_f32 v19, v19, v54
    v_mul_f32 v20, v20, v54
    v_mul_f32 v21, v21, v54
    v_mul_f32 v22, v22, v54
    v_mul_f32 v23, v23, v54
    v_mul_f32 v10, v10, v54
    v_sub_f32 v56, v52, v11
    v_sub_f32 v57, v53, v11
    s_branch L_back_0_2
L_resc_0_3:
    v_mul_f32 v52, s65, v52
    v_mul_f32 v53, s65, v53
    v_max_f32 v58, v52, v53
    s_nop 1
    v_max_f32_dpp v58, v58, v58 row_ror:8 row_mask:0xf bank_mask:0xf
    s_nop 1
    v_readlane_b32 s72, v58, 0
    v_readlane_b32 s73, v58, 16
    v_readlane_b32 s74, v58, 32
    v_readlane_b32 s75, v58, 48
    s_nop 3
    v_max_f32 v58, s72, v11
    v_max_f32 v58, s73, v58
    v_max_f32 v58, s74, v58
    v_max_f32 v58, s75, v58
    v_sub_f32 v54, v11, v58
    v_exp_f32 v54, v54
    v_mov_b32 v11, v58
    s_nop 7
    v_mul_f32 v12, v12, v54
    v_mul_f32 v13, v13, v54
    v_mul_f32 v14, v14, v54
    v_mul_f32 v15, v15, v54
    v_mul_f32 v16, v16, v54
    v_mul_f32 v17, v17, v54
    v_mul_f32 v18, v18, v54
    v_mul_f32 v19, v19, v54
    v_mul_f32 v20, v20, v54
    v_mul_f32 v21, v21, v54
    v_mul_f32 v22, v22, v54
    v_mul_f32 v23, v23, v54
    v_mul_f32 v10, v10, v54
    v_sub_f32 v56, v52, v11
    v_sub_f32 v57, v53, v11
    s_branch L_back_0_3
L_main_1:
    s_cmp_ge_u32 s84, s85
    s_cbranch_scc1 L_fin
    s_add_u32 s84, s84, 1
    s_waitcnt vmcnt(42)
    v_mfma_f32_16x16x32_bf16 v[36:39], v[64:67], v[24:27], 0
    v_mfma_f32_16x16x32_bf16 v[40:43], v[76:79], v[24:27], 0
    v_mfma_f32_16x16x32_bf16 v[36:39], v[68:71], v[28:31], v[36:39]
    v_mfma_f32_16x16x32_bf16 v[40:43], v[80:83], v[28:31], v[40:43]
    v_mfma_f32_16x16x32_bf16 v[36:39], v[72:75], v[32:35], v[36:39]
    v_mfma_f32_16x16x32_bf16 v[40:43], v[84:87], v[32:35], v[40:43]
    buffer_load_dwordx4 v[64:67], v4, s[32:35], s63 offen offset:0 nt
    buffer_load_dwordx4 v[68:71], v4, s[32:35], s63 offen offset:256 nt
    buffer_load_dwordx4 v[72:75], v4, s[32:35], s63 offen offset:512 nt
    buffer_load_dwordx4 v[76:79], v4, s[32:35], s63 offen offset:3072 nt
    buffer_load_dwordx4 v[80:83], v4, s[32:35], s63 offen offset:3328 nt
    buffer_load_dwordx4 v[84:87], v4, s[32:35], s63 offen offset:3584 nt
    s_nop 1
    v_cndmask_b32 v52, v36, v37, s[68:69]
    v_cndmask_b32 v54, v38, v39, s[68:69]
    v_cndmask_b32 v53, v40, v41, s[68:69]
    v_cndmask_b32 v55, v42, v43, s[68:69]
    v_cndmask_b32 v52, v52, v54, s[70:71]
    v_cndmask_b32 v53, v53, v55, s[70:71]
    s_nop 0
    v_add_f32_dpp v52, v52, v52 quad_perm:[1,0,3,2] row_mask:0xf bank_mask:0xf
    v_add_f32_dpp v53, v53, v53 quad_perm:[1,0,3,2] row_mask:0xf bank_mask:0xf
    s_nop 0
    v_add_f32_dpp v52, v52, v52 quad_perm:[2,3,0,1] row_mask:0xf bank_mask:0xf
    v_add_f32_dpp v53, v53, v53 quad_perm:[2,3,0,1] row_mask:0xf bank_mask:0xf
    v_fma_f32 v56, v52, s65, -v11
    v_fma_f32 v57, v53, s65, -v11
    v_max_f32 v58, v56, v57
    v_cmp_lt_f32 vcc, s66, v58
    s_cbranch_vccnz L_resc_1_0
L_back_1_0:
    v_exp_f32 v56, v56
    v_exp_f32 v57, v57
    s_nop 0
    v_cvt_pk_bf16_f32 v52, v56, v56
    v_cvt_pk_bf16_f32 v53, v57, v57
    v_add_f32 v10, v10, v56
    v_add_f32 v10, v10, v57
    v_and_b32 v44, v52, v6
    v_and_b32 v45, v52, v7
    v_and_b32 v46, v52, v8
    v_and_b32 v47, v52, v9
    v_and_b32 v48, v53, v6
    v_and_b32 v49, v53, v7
    v_and_b32 v50, v53, v8
    v_and_b32 v51, v53, v9
    s_waitcnt vmcnt(42)
    v_mfma_f32_16x16x32_bf16 v[12:15], v[88:91], v[44:47], v[12:15]
    v_mfma_f32_16x16x32_bf16 v[16:19], v[92:95], v[44:47], v[16:19]
    v_mfma_f32_16x16x32_bf16 v[20:23], v[96:99], v[44:47], v[20:23]
    v_mfma_f32_16x16x32_bf16 v[12:15], v[100:103], v[48:51], v[12:15]
    v_mfma_f32_16x16x32_bf16 v[16:19], v[104:107], v[48:51], v[16:19]
    v_mfma_f32_16x16x32_bf16 v[20:23], v[108:111], v[48:51], v[20:23]
    buffer_load_dwordx4 v[88:91], v5, s[36:39], s63 offen offset:0 nt
    buffer_load_dwordx4 v[92:95], v5, s[36:39], s63 offen offset:256 nt
    buffer_load_dwordx4 v[96:99], v5, s[36:39], s63 offen offset:512 nt
    buffer_load_dwordx4 v[100:103], v5, s[36:39], s63 offen offset:3072 nt
    buffer_load_dwordx4 v[104:107], v5, s[36:39], s63 offen offset:3328 nt
    buffer_load_dwordx4 v[108:111], v5, s[36:39], s63 offen offset:3584 nt
    s_add_u32 s81, s81, s95
    s_sub_u32 s67, s67, 1
    s_cmp_lg_u32 s67, 0
    s_cbranch_scc1 L_ar_17
    s_mov_b32 s67, s79
    s_mov_b32 s79, 0
    s_mov_b32 s81, s80
    s_mov_b32 s95, 0xffffa000
L_ar_17:
    s_cmp_gt_i32 s67, 0
    s_cselect_b32 s63, s81, 0x80000000
    s_cmp_ge_u32 s84, s85
    s_cbranch_scc1 L_fin
    s_add_u32 s84, s84, 1
    s_waitcnt vmcnt(42)
    v_mfma_f32_16x16x32_bf16 v[36:39], v[112:115], v[24:27], 0
    v_mfma_f32_16x16x32_bf16 v[40:43], v[124:127], v[24:27], 0
    v_mfma_f32_16x16x32_bf16 v[36:39], v[116:119], v[28:31], v[36:39]
    v_mfma_f32_16x16x32_bf16 v[40:43], v[128:131], v[28:31], v[40:43]
    v_mfma_f32_16x16x32_bf16 v[36:39], v[120:123], v[32:35], v[36:39]
    v_mfma_f32_16x16x32_bf16 v[40:43], v[132:135], v[32:35], v[40:43]
    buffer_load_dwordx4 v[112:115], v4, s[32:35], s63 offen offset:0 nt
    buffer_load_dwordx4 v[116:119], v4, s[32:35], s63 offen offset:256 nt
    buffer_load_dwordx4 v[120:123], v4, s[32:35], s63 offen offset:512 nt
    buffer_load_dwordx4 v[124:127], v4, s[32:35], s63 offen offset:3072 nt
    buffer_load_dwordx4 v[128:131], v4, s[32:35], s63 offen offset:3328 nt
    buffer_load_dwordx4 v[132:135], v4, s[32:35], s63 offen offset:3584 nt
    s_nop 1
    v_cndmask_b32 v52, v36, v37, s[68:69]
    v_cndmask_b32 v54, v38, v39, s[68:69]
    v_cndmask_b32 v53, v40, v41, s[68:69]
    v_cndmask_b32 v55, v42, v43, s[68:69]
    v_cndmask_b32 v52, v52, v54, s[70:71]
    v_cndmask_b32 v53, v53, v55, s[70:71]
    s_nop 0
    v_add_f32_dpp v52, v52, v52 quad_perm:[1,0,3,2] row_mask:0xf bank_mask:0xf
    v_add_f32_dpp v53, v53, v53 quad_perm:[1,0,3,2] row_mask:0xf bank_mask:0xf
    s_nop 0
    v_add_f32_dpp v52, v52, v52 quad_perm:[2,3,0,1] row_mask:0xf bank_mask:0xf
    v_add_f32_dpp v53, v53, v53 quad_perm:[2,3,0,1] row_mask:0xf bank_mask:0xf
    v_fma_f32 v56, v52, s65, -v11
    v_fma_f32 v57, v53, s65, -v11
    v_max_f32 v58, v56, v57
    v_cmp_lt_f32 vcc, s66, v58
    s_cbranch_vccnz L_resc_1_1
L_back_1_1:
    v_exp_f32 v56, v56
    v_exp_f32 v57, v57
    s_nop 0
    v_cvt_pk_bf16_f32 v52, v56, v56
    v_cvt_pk_bf16_f32 v53, v57, v57
    v_add_f32 v10, v10, v56
    v_add_f32 v10, v10, v57
    v_and_b32 v44, v52, v6
    v_and_b32 v45, v52, v7
    v_and_b32 v46, v52, v8
    v_and_b32 v47, v52, v9
    v_and_b32 v48, v53, v6
    v_and_b32 v49, v53, v7
    v_and_b32 v50, v53, v8
    v_and_b32 v51, v53, v9
    s_waitcnt vmcnt(42)
    v_mfma_f32_16x16x32_bf16 v[12:15], v[136:139], v[44:47], v[12:15]
    v_mfma_f32_16x16x32_bf16 v[16:19], v[140:143], v[44:47], v[16:19]
    v_mfma_f32_16x16x32_bf16 v[20:23], v[144:147], v[44:47], v[20:23]
    v_mfma_f32_16x16x32_bf16 v[12:15], v[148:151], v[48:51], v[12:15]
    v_mfma_f32_16x16x32_bf16 v[16:19], v[152:155], v[48:51], v[16:19]
    v_mfma_f32_16x16x32_bf16 v[20:23], v[156:159], v[48:51], v[20:23]
    buffer_load_dwordx4 v[136:139], v5, s[36:39], s63 offen offset:0 nt
    buffer_load_dwordx4 v[140:143], v5, s[36:39], s63 offen offset:256 nt
    buffer_load_dwordx4 v[144:147], v5, s[36:39], s63 offen offset:512 nt
    buffer_load_dwordx4 v[148:151], v5, s[36:39], s63 offen offset:3072 nt
    buffer_load_dwordx4 v[152:155], v5, s[36:39], s63 offen offset:3328 nt
    buffer_load_dwordx4 v[156:159], v5, s[36:39], s63 offen offset:3584 nt
    s_add_u32 s81, s81, s95
    s_sub_u32 s67, s67, 1
    s_cmp_lg_u32 s67, 0
    s_cbranch_scc1 L_ar_18
    s_mov_b32 s67, s79
    s_mov_b32 s79, 0
    s_mov_b32 s81, s80
    s_mov_b32 s95, 0xffffa000
L_ar_18:
    s_cmp_gt_i32 s67, 0
    s_cselect_b32 s63, s81, 0x80000000
    s_cmp_ge_u32 s84, s85
    s_cbranch_scc1 L_fin
    s_add_u32 s84, s84, 1
    s_waitcnt vmcnt(42)
    v_mfma_f32_16x16x32_bf16 v[36:39], v[160:163], v[24:27], 0
    v_mfma_f32_16x16x32_bf16 v[40:43], v[172:175], v[24:27], 0
    v_mfma_f32_16x16x32_bf16 v[36:39], v[164:167], v[28:31], v[36:39]
    v_mfma_f32_16x16x32_bf16 v[40:43], v[176:179], v[28:31], v[40:43]
    v_mfma_f32_16x16x32_bf16 v[36:39], v[168:171], v[32:35], v[36:39]
    v_mfma_f32_16x16x32_bf16 v[40:43], v[180:183], v[32:35], v[40:43]
    buffer_load_dwordx4 v[160:163], v4, s[32:35], s63 offen offset:0 nt
    buffer_load_dwordx4 v[164:167], v4, s[32:35], s63 offen offset:256 nt
    buffer_load_dwordx4 v[168:171], v4, s[32:35], s63 offen offset:512 nt
    buffer_load_dwordx4 v[172:175], v4, s[32:35], s63 offen offset:3072 nt
    buffer_load_dwordx4 v[176:179], v4, s[32:35], s63 offen offset:3328 nt
    buffer_load_dwordx4 v[180:183], v4, s[32:35], s63 offen offset:3584 nt
    s_nop 1
    v_cndmask_b32 v52, v36, v37, s[68:69]
    v_cndmask_b32 v54, v38, v39, s[68:69]
    v_cndmask_b32 v53, v40, v41, s[68:69]
    v_cndmask_b32 v55, v42, v43, s[68:69]
    v_cndmask_b32 v52, v52, v54, s[70:71]
    v_cndmask_b32 v53, v53, v55, s[70:71]
    s_nop 0
    v_add_f32_dpp v52, v52, v52 quad_perm:[1,0,3,2] row_mask:0xf bank_mask:0xf
    v_add_f32_dpp v53, v53, v53 quad_perm:[1,0,3,2] row_mask:0xf bank_mask:0xf
    s_nop 0
    v_add_f32_dpp v52, v52, v52 quad_perm:[2,3,0,1] row_mask:0xf bank_mask:0xf
    v_add_f32_dpp v53, v53, v53 quad_perm:[2,3,0,1] row_mask:0xf bank_mask:0xf
    v_fma_f32 v56, v52, s65, -v11
    v_fma_f32 v57, v53, s65, -v11
    v_max_f32 v58, v56, v57
    v_cmp_lt_f32 vcc, s66, v58
    s_cbranch_vccnz L_resc_1_2
L_back_1_2:
    v_exp_f32 v56, v56
    v_exp_f32 v57, v57
    s_nop 0
    v_cvt_pk_bf16_f32 v52, v56, v56
    v_cvt_pk_bf16_f32 v53, v57, v57
    v_add_f32 v10, v10, v56
    v_add_f32 v10, v10, v57
    v_and_b32 v44, v52, v6
    v_and_b32 v45, v52, v7
    v_and_b32 v46, v52, v8
    v_and_b32 v47, v52, v9
    v_and_b32 v48, v53, v6
    v_and_b32 v49, v53, v7
    v_and_b32 v50, v53, v8
    v_and_b32 v51, v53, v9
    s_waitcnt vmcnt(42)
    v_mfma_f32_16x16x32_bf16 v[12:15], v[184:187], v[44:47], v[12:15]
    v_mfma_f32_16x16x32_bf16 v[16:19], v[188:191], v[44:47], v[16:19]
    v_mfma_f32_16x16x32_bf16 v[20:23], v[192:195], v[44:47], v[20:23]
    v_mfma_f32_16x16x32_bf16 v[12:15], v[196:199], v[48:51], v[12:15]
    v_mfma_f32_16x16x32_bf16 v[16:19], v[200:203], v[48:51], v[16:19]
    v_mfma_f32_16x16x32_bf16 v[20:23], v[204:207], v[48:51], v[20:23]
    buffer_load_dwordx4 v[184:187], v5, s[36:39], s63 offen offset:0 nt
    buffer_load_dwordx4 v[188:191], v5, s[36:39], s63 offen offset:256 nt
    buffer_load_dwordx4 v[192:195], v5, s[36:39], s63 offen offset:512 nt
    buffer_load_dwordx4 v[196:199], v5, s[36:39], s63 offen offset:3072 nt
    buffer_load_dwordx4 v[200:203], v5, s[36:39], s63 offen offset:3328 nt
    buffer_load_dwordx4 v[204:207], v5, s[36:39], s63 offen offset:3584 nt
    s_add_u32 s81, s81, s95
    s_sub_u32 s67, s67, 1
    s_cmp_lg_u32 s67, 0
    s_cbranch_scc1 L_ar_19
    s_mov_b32 s67, s79
    s_mov_b32 s79, 0
    s_mov_b32 s81, s80
    s_mov_b32 s95, 0xffffa000
L_ar_19:
    s_cmp_gt_i32 s67, 0
    s_cselect_b32 s63, s81, 0x80000000
    s_cmp_ge_u32 s84, s85
    s_cbranch_scc1 L_fin
    s_add_u32 s84, s84, 1
    s_waitcnt vmcnt(42)
    v_mfma_f32_16x16x32_bf16 v[36:39], v[208:211], v[24:27], 0
    v_mfma_f32_16x16x32_bf16 v[40:43], v[220:223], v[24:27], 0
    v_mfma_f32_16x16x32_bf16 v[36:39], v[212:215], v[28:31], v[36:39]
    v_mfma_f32_16x16x32_bf16 v[40:43], v[224:227], v[28:31], v[40:43]
    v_mfma_f32_16x16x32_bf16 v[36:39], v[216:219], v[32:35], v[36:39]
    v_mfma_f32_16x16x32_bf16 v[40:43], v[228:231], v[32:35], v[40:43]
    buffer_load_dwordx4 v[208:211], v4, s[32:35], s63 offen offset:0 nt
    buffer_load_dwordx4 v[212:215], v4, s[32:35], s63 offen offset:256 nt
    buffer_load_dwordx4 v[216:219], v4, s[32:35], s63 offen offset:512 nt
    buffer_load_dwordx4 v[220:223], v4, s[32:35], s63 offen offset:3072 nt
    buffer_load_dwordx4 v[224:227], v4, s[32:35], s63 offen offset:3328 nt
    buffer_load_dwordx4 v[228:231], v4, s[32:35], s63 offen offset:3584 nt
    s_nop 1
    v_cndmask_b32 v52, v36, v37, s[68:69]
    v_cndmask_b32 v54, v38, v39, s[68:69]
    v_cndmask_b32 v53, v40, v41, s[68:69]
    v_cndmask_b32 v55, v42, v43, s[68:69]
    v_cndmask_b32 v52, v52, v54, s[70:71]
    v_cndmask_b32 v53, v53, v55, s[70:71]
    s_nop 0
    v_add_f32_dpp v52, v52, v52 quad_perm:[1,0,3,2] row_mask:0xf bank_mask:0xf
    v_add_f32_dpp v53, v53, v53 quad_perm:[1,0,3,2] row_mask:0xf bank_mask:0xf
    s_nop 0
    v_add_f32_dpp v52, v52, v52 quad_perm:[2,3,0,1] row_mask:0xf bank_mask:0xf
    v_add_f32_dpp v53, v53, v53 quad_perm:[2,3,0,1] row_mask:0xf bank_mask:0xf
    v_fma_f32 v56, v52, s65, -v11
    v_fma_f32 v57, v53, s65, -v11
    v_max_f32 v58, v56, v57
    v_cmp_lt_f32 vcc, s66, v58
    s_cbranch_vccnz L_resc_1_3
L_back_1_3:
    v_exp_f32 v56, v56
    v_exp_f32 v57, v57
    s_nop 0
    v_cvt_pk_bf16_f32 v52, v56, v56
    v_cvt_pk_bf16_f32 v53, v57, v57
    v_add_f32 v10, v10, v56
    v_add_f32 v10, v10, v57
    v_and_b32 v44, v52, v6
    v_and_b32 v45, v52, v7
    v_and_b32 v46, v52, v8
    v_and_b32 v47, v52, v9
    v_and_b32 v48, v53, v6
    v_and_b32 v49, v53, v7
    v_and_b32 v50, v53, v8
    v_and_b32 v51, v53, v9
    s_waitcnt vmcnt(42)
    v_mfma_f32_16x16x32_bf16 v[12:15], v[232:235], v[44:47], v[12:15]
    v_mfma_f32_16x16x32_bf16 v[16:19], v[236:239], v[44:47], v[16:19]
    v_mfma_f32_16x16x32_bf16 v[20:23], v[240:243], v[44:47], v[20:23]
    v_mfma_f32_16x16x32_bf16 v[12:15], v[244:247], v[48:51], v[12:15]
    v_mfma_f32_16x16x32_bf16 v[16:19], v[248:251], v[48:51], v[16:19]
    v_mfma_f32_16x16x32_bf16 v[20:23], v[252:255], v[48:51], v[20:23]
    buffer_load_dwordx4 v[232:235], v5, s[36:39], s63 offen offset:0 nt
    buffer_load_dwordx4 v[236:239], v5, s[36:39], s63 offen offset:256 nt
    buffer_load_dwordx4 v[240:243], v5, s[36:39], s63 offen offset:512 nt
    buffer_load_dwordx4 v[244:247], v5, s[36:39], s63 offen offset:3072 nt
    buffer_load_dwordx4 v[248:251], v5, s[36:39], s63 offen offset:3328 nt
    buffer_load_dwordx4 v[252:255], v5, s[36:39], s63 offen offset:3584 nt
    s_add_u32 s81, s81, s95
    s_sub_u32 s67, s67, 1
    s_cmp_lg_u32 s67, 0
    s_cbranch_scc1 L_ar_20
    s_mov_b32 s67, s79
    s_mov_b32 s79, 0
    s_mov_b32 s81, s80
    s_mov_b32 s95, 0xffffa000
L_ar_20:
    s_cmp_gt_i32 s67, 0
    s_cselect_b32 s63, s81, 0x80000000
    s_add_u32 s64, s64, 1
    s_cmp_lg_u32 s64, s86
    s_cbranch_scc1 L_main_1
    v_mov_b32 v62, 4132
    s_mov_b32 s94, 131072
L_lw_21:
    ds_read_b32 v63, v62
    s_waitcnt lgkmcnt(0)
    v_readfirstlane_b32 s87, v63
    s_nop 3
    s_cmp_ge_u32 s87, 1
    s_cbranch_scc1 L_lwd_22
    s_sub_u32 s94, s94, 1
    s_cmp_eq_u32 s94, 0
    s_cbranch_scc1 L_lwd_22
    s_sleep 1
    s_branch L_lw_21
L_lwd_22:
    s_and_b32 s72, s87, 0xff
    s_bfe_u32 s73, s87, 0x80008
    s_bfe_u32 s74, s87, 0x80010
    s_mov_b32 s75, 0
    s_mov_b32 s76, s72
    s_cmp_ge_u32 s59, 1
    s_cselect_b32 s75, s72, s75
    s_cselect_b32 s76, s73, s76
    s_cmp_ge_u32 s59, 2
    s_cselect_b32 s75, s73, s75
    s_cselect_b32 s76, s74, s76
    s_cmp_ge_u32 s59, 3
    s_cselect_b32 s75, s74, s75
    s_cselect_b32 s76, 128, s76
    s_sub_u32 s85, s76, s75
    s_lshl_b32 s72, s59, 5
    s_add_u32 s72, s72, 8
    s_sub_u32 s79, s72, s75
    s_add_u32 s73, s59, 1
    s_and_b32 s73, s73, 2
    s_cmp_eq_u32 s73, 0
    s_cselect_b32 s79, 0, s79
    s_sub_u32 s67, s85, s79
    s_lshl_b32 s72, s86, 2
    s_add_u32 s72, s72, 4
    s_sub_u32 s67, s67, s72
    s_cmp_lg_u32 s67, 0
    s_cbranch_scc1 L_ar_23
    s_mov_b32 s67, s79
    s_mov_b32 s79, 0
    s_mov_b32 s81, s80
    s_mov_b32 s95, 0xffffa000
L_ar_23:
    s_cmp_gt_i32 s67, 0
    s_cselect_b32 s63, s81, 0x80000000
    s_branch L_main_1
L_resc_1_0:
    v_mul_f32 v52, s65, v52
    v_mul_f32 v53, s65, v53
    v_max_f32 v58, v52, v53
    s_nop 1
    v_max_f32_dpp v58, v58, v58 row_ror:8 row_mask:0xf bank_mask:0xf
    s_nop 1
    v_readlane_b32 s72, v58, 0
    v_readlane_b32 s73, v58, 16
    v_readlane_b32 s74, v58, 32
    v_readlane_b32 s75, v58, 48
    s_nop 3
    v_max_f32 v58, s72, v11
    v_max_f32 v58, s73, v58
    v_max_f32 v58, s74, v58
    v_max_f32 v58, s75, v58
    v_sub_f32 v54, v11, v58
    v_exp_f32 v54, v54
    v_mov_b32 v11, v58
    s_nop 7
    v_mul_f32 v12, v12, v54
    v_mul_f32 v13, v13, v54
    v_mul_f32 v14, v14, v54
    v_mul_f32 v15, v15, v54
    v_mul_f32 v16, v16, v54
    v_mul_f32 v17, v17, v54
    v_mul_f32 v18, v18, v54
    v_mul_f32 v19, v19, v54
    v_mul_f32 v20, v20, v54
    v_mul_f32 v21, v21, v54
    v_mul_f32 v22, v22, v54
    v_mul_f32 v23, v23, v54
    v_mul_f32 v10, v10, v54
    v_sub_f32 v56, v52, v11
    v_sub_f32 v57, v53, v11
    s_branch L_back_1_0
L_resc_1_1:
    v_mul_f32 v52, s65, v52
    v_mul_f32 v53, s65, v53
    v_max_f32 v58, v52, v53
    s_nop 1
    v_max_f32_dpp v58, v58, v58 row_ror:8 row_mask:0xf bank_mask:0xf
    s_nop 1
    v_readlane_b32 s72, v58, 0
    v_readlane_b32 s73, v58, 16
    v_readlane_b32 s74, v58, 32
    v_readlane_b32 s75, v58, 48
    s_nop 3
    v_max_f32 v58, s72, v11
    v_max_f32 v58, s73, v58
    v_max_f32 v58, s74, v58
    v_max_f32 v58, s75, v58
    v_sub_f32 v54, v11, v58
    v_exp_f32 v54, v54
    v_mov_b32 v11, v58
    s_nop 7
    v_mul_f32 v12, v12, v54
    v_mul_f32 v13, v13, v54
    v_mul_f32 v14, v14, v54
    v_mul_f32 v15, v15, v54
    v_mul_f32 v16, v16, v54
    v_mul_f32 v17, v17, v54
    v_mul_f32 v18, v18, v54
    v_mul_f32 v19, v19, v54
    v_mul_f32 v20, v20, v54
    v_mul_f32 v21, v21, v54
    v_mul_f32 v22, v22, v54
    v_mul_f32 v23, v23, v54
    v_mul_f32 v10, v10, v54
    v_sub_f32 v56, v52, v11
    v_sub_f32 v57, v53, v11
    s_branch L_back_1_1
L_resc_1_2:
    v_mul_f32 v52, s65, v52
    v_mul_f32 v53, s65, v53
    v_max_f32 v58, v52, v53
    s_nop 1
    v_max_f32_dpp v58, v58, v58 row_ror:8 row_mask:0xf bank_mask:0xf
    s_nop 1
    v_readlane_b32 s72, v58, 0
    v_readlane_b32 s73, v58, 16
    v_readlane_b32 s74, v58, 32
    v_readlane_b32 s75, v58, 48
    s_nop 3
    v_max_f32 v58, s72, v11
    v_max_f32 v58, s73, v58
    v_max_f32 v58, s74, v58
    v_max_f32 v58, s75, v58
    v_sub_f32 v54, v11, v58
    v_exp_f32 v54, v54
    v_mov_b32 v11, v58
    s_nop 7
    v_mul_f32 v12, v12, v54
    v_mul_f32 v13, v13, v54
    v_mul_f32 v14, v14, v54
    v_mul_f32 v15, v15, v54
    v_mul_f32 v16, v16, v54
    v_mul_f32 v17, v17, v54
    v_mul_f32 v18, v18, v54
    v_mul_f32 v19, v19, v54
    v_mul_f32 v20, v20, v54
    v_mul_f32 v21, v21, v54
    v_mul_f32 v22, v22, v54
    v_mul_f32 v23, v23, v54
    v_mul_f32 v10, v10, v54
    v_sub_f32 v56, v52, v11
    v_sub_f32 v57, v53, v11
    s_branch L_back_1_2
L_resc_1_3:
    v_mul_f32 v52, s65, v52
    v_mul_f32 v53, s65, v53
    v_max_f32 v58, v52, v53
    s_nop 1
    v_max_f32_dpp v58, v58, v58 row_ror:8 row_mask:0xf bank_mask:0xf
    s_nop 1
    v_readlane_b32 s72, v58, 0
    v_readlane_b32 s73, v58, 16
    v_readlane_b32 s74, v58, 32
    v_readlane_b32 s75, v58, 48
    s_nop 3
    v_max_f32 v58, s72, v11
    v_max_f32 v58, s73, v58
    v_max_f32 v58, s74, v58
    v_max_f32 v58, s75, v58
    v_sub_f32 v54, v11, v58
    v_exp_f32 v54, v54
    v_mov_b32 v11, v58
    s_nop 7
    v_mul_f32 v12, v12, v54
    v_mul_f32 v13, v13, v54
    v_mul_f32 v14, v14, v54
    v_mul_f32 v15, v15, v54
    v_mul_f32 v16, v16, v54
    v_mul_f32 v17, v17, v54
    v_mul_f32 v18, v18, v54
    v_mul_f32 v19, v19, v54
    v_mul_f32 v20, v20, v54
    v_mul_f32 v21, v21, v54
    v_mul_f32 v22, v22, v54
    v_mul_f32 v23, v23, v54
    v_mul_f32 v10, v10, v54
    v_sub_f32 v56, v52, v11
    v_sub_f32 v57, v53, v11
    s_branch L_back_1_3
L_fin:
    s_waitcnt vmcnt(0)
    s_nop 7
    s_nop 3
    v_add_f32_dpp v10, v10, v10 row_ror:8 row_mask:0xf bank_mask:0xf
    s_nop 1
    v_readlane_b32 s72, v10, 0
    v_readlane_b32 s73, v10, 16
    v_readlane_b32 s74, v10, 32
    v_readlane_b32 s75, v10, 48
    s_nop 3
    v_mov_b32 v53, s72
    v_add_f32 v53, s73, v53
    v_add_f32 v53, s74, v53
    v_add_f32 v53, s75, v53
    v_mov_b32 v52, v11
    s_mul_i32 s72, s30, 3328
    v_lshlrev_b32 v54, 4, v1
    v_add_u32 v54, s72, v54
    ds_write_b128 v54, v[12:15] offset:4352
    ds_write_b128 v54, v[16:19] offset:5376
    ds_write_b128 v54, v[20:23] offset:6400
    v_mov_b32 v55, s72
    ds_write_b64 v55, v[52:53] offset:7424
    s_cmp_eq_u32 s60, 0
    s_cbranch_scc0 L_g1_24
    s_waitcnt lgkmcnt(0)
    v_mov_b32 v62, 4096
    v_mov_b32 v63, 1
    s_mov_b64 exec, 1
    ds_add_u32 v62, v63
    s_mov_b64 exec, -1
    v_mov_b32 v62, 4096
    s_mov_b32 s94, 131072
L_lw_26:
    ds_read_b32 v63, v62
    s_waitcnt lgkmcnt(0)
    v_readfirstlane_b32 s87, v63
    s_nop 3
    s_cmp_ge_u32 s87, 4
    s_cbranch_scc1 L_lwd_27
    s_sub_u32 s94, s94, 1
    s_cmp_eq_u32 s94, 0
    s_cbranch_scc1 L_lwd_27
    s_sleep 1
    s_branch L_lw_26
L_lwd_27:
    s_branch L_g2_25
L_g1_24:
    s_waitcnt lgkmcnt(0)
    v_mov_b32 v62, 4100
    v_mov_b32 v63, 1
    s_mov_b64 exec, 1
    ds_add_u32 v62, v63
    s_mov_b64 exec, -1
    v_mov_b32 v62, 4100
    s_mov_b32 s94, 131072
L_lw_28:
    ds_read_b32 v63, v62
    s_waitcnt lgkmcnt(0)
    v_readfirstlane_b32 s87, v63
    s_nop 3
    s_cmp_ge_u32 s87, 4
    s_cbranch_scc1 L_lwd_29
    s_sub_u32 s94, s94, 1
    s_cmp_eq_u32 s94, 0
    s_cbranch_scc1 L_lwd_29
    s_sleep 1
    s_branch L_lw_28
L_lwd_29:
L_g2_25:
    s_mul_i32 s72, s31, 48
    v_add_u32 v52, s72, v1
    v_min_u32 v52, 191, v52
    v_lshrrev_b32 v55, 3, v52
    v_and_b32 v56, 7, v52
    v_and_b32 v53, 15, v55
    v_lshrrev_b32 v54, 2, v53
    v_lshlrev_b32 v54, 4, v54
    v_add_u32 v54, v54, v56
    v_lshlrev_b32 v54, 4, v54
    v_and_b32 v53, 3, v53
    v_lshl_add_u32 v53, v53, 2, v54
    v_lshrrev_b32 v54, 4, v55
    v_lshl_add_u32 v53, v54, 10, v53
    v_cmp_gt_u32 vcc, 8, v55
    v_add_u32 v54, 8, v55
    v_subrev_u32 v55, 8, v55
    v_cndmask_b32 v55, v55, v54, vcc
    v_cndmask_b32 v54, 0, 1, vcc
    v_lshlrev_b32 v54, 10, v54
    v_sub_u32 v54, 2048, v54
    v_add_u32 v56, 8, v56
    v_and_b32 v61, 3, v55
    v_lshl_add_u32 v54, v61, 2, v54
    v_lshrrev_b32 v55, 2, v55
    v_lshl_add_u32 v55, v55, 4, v56
    v_lshl_add_u32 v54, v55, 4, v54
    s_mul_i32 s72, s60, 13312
    v_add_u32 v53, s72, v53
    v_add_u32 v54, s72, v54
    v_mov_b32 v55, s72
    ds_read_b32 v36, v53 offset:4352
    ds_read_b32 v37, v54 offset:4352
    ds_read_b64 v[44:45], v55 offset:7424
    ds_read_b32 v38, v53 offset:7680
    ds_read_b32 v39, v54 offset:7680
    ds_read_b64 v[46:47], v55 offset:10752
    ds_read_b32 v40, v53 offset:11008
    ds_read_b32 v41, v54 offset:11008
    ds_read_b64 v[48:49], v55 offset:14080
    ds_read_b32 v42, v53 offset:14336
    ds_read_b32 v43, v54 offset:14336
    ds_read_b64 v[50:51], v55 offset:17408
    s_waitcnt lgkmcnt(0)
    v_max_f32 v56, v44, v46
    v_max3_f32 v56, v56, v48, v50
    v_sub_f32 v44, v44, v56
    v_exp_f32 v44, v44
    v_add_f32 v36, v36, v37
    v_sub_f32 v46, v46, v56
    v_exp_f32 v46, v46
    v_add_f32 v38, v38, v39
    v_sub_f32 v48, v48, v56
    v_exp_f32 v48, v48
    v_add_f32 v40, v40, v41
    v_sub_f32 v50, v50, v56
    v_exp_f32 v50, v50
    v_add_f32 v42, v42, v43
    s_nop 0
    v_mul_f32 v64, v36, v44
    v_mul_f32 v58, v45, v44
    v_fmac_f32 v64, v38, v46
    v_fmac_f32 v58, v47, v46
    v_fmac_f32 v64, v40, v48
    v_fmac_f32 v58, v49, v48
    v_fmac_f32 v64, v42, v50
    v_fmac_f32 v58, v51, v50
    s_nop 1
    v_mov_b32_dpp v65, v64 quad_perm:[1,0,3,2] row_mask:0xf bank_mask:0xf
    s_lshl_b32 s72, s62, 2
    s_add_u32 s72, s72, s59
    s_lshl_b32 s72, s72, 11
    v_lshlrev_b32 v52, 3, v52
    v_cmp_eq_u32 vcc, 48, v1
    v_mov_b32 v59, 1536
    s_nop 0
    v_cndmask_b32 v52, v52, v59, vcc
    v_cndmask_b32 v64, v64, v56, vcc
    v_cndmask_b32 v65, v65, v58, vcc
    s_mov_b32 s74, 0x55555555
    s_mov_b32 s75, 0x00015555
    s_mov_b64 exec, s[74:75]
    v_mov_b32 v66, s14
    v_mov_b32 v67, s15
    buffer_store_dwordx4 v[64:67], v52, s[40:43], s72 offen offset:0 sc1
    s_mov_b64 exec, -1
    s_cmp_eq_u32 s60, 0
    s_cbranch_scc1 L_cont_30
    s_waitcnt lgkmcnt(0)
    v_mov_b32 v62, 4104
    v_mov_b32 v63, 1
    s_mov_b64 exec, 1
    ds_add_u32 v62, v63
    s_mov_b64 exec, -1
    s_waitcnt lgkmcnt(0)
    s_endpgm
L_cont_30:
    s_cmp_eq_u32 s31, 0
    s_cbranch_scc0 L_ng_31
    s_memrealtime s[96:97]
    s_waitcnt lgkmcnt(0)
    s_sub_u32 s97, s96, s78
    s_mov_b32 s72, 33
    s_cmp_eq_u32 s93, 1
    s_cselect_b32 s72, 61, s72
    s_cmp_eq_u32 s93, 2
    s_cselect_b32 s72, 27, s72
    s_mul_i32 s72, s72, s97
    s_lshr_b32 s72, s72, 10
    s_add_u32 s96, s96, s72
    v_mov_b32 v72, s96
    v_mov_b32 v73, s97
    s_lshl_b32 s72, s59, 4
    s_add_u32 s73, s83, s72
    v_mov_b32 v52, 0
    s_mov_b64 exec, 1
    v_mov_b32 v74, s14
    v_mov_b32 v75, s15
    buffer_store_dwordx4 v[72:75], v52, s[40:43], s73 offen offset:0 sc1
    s_mov_b64 exec, -1
    s_nop 1
    v_and_b32 v52, 3, v1
    v_lshlrev_b32 v52, 4, v52
    s_mov_b64 exec, 0xf
    s_mov_b32 s94, 131072
L_lp_32:
    buffer_load_dwordx4 v[76:79], v52, s[40:43], s83 offen sc1
    s_waitcnt vmcnt(0)
    v_xor_b32 v76, s14, v78
    v_xor_b32 v77, s15, v79
    v_or_b32 v76, v76, v77
    v_cmp_ne_u32 vcc, 0, v76
    s_cbranch_vccz L_lpd_33
    s_sub_u32 s94, s94, 1
    s_cmp_eq_u32 s94, 0
    s_cbranch_scc1 L_lpd_33
    s_sleep 16
    s_branch L_lp_32
L_lpd_33:
    s_mov_b64 exec, -1
    buffer_load_dwordx4 v[76:79], v52, s[40:43], s83 offen sc1
    s_waitcnt vmcnt(0)
    s_nop 0
    v_readlane_b32 s75, v76, 0
    s_nop 3
    v_subrev_u32 v53, s75, v76
    v_cvt_f32_i32 v53, v53
    v_cvt_f32_u32 v54, v77
    v_rcp_f32 v54, v54
    s_nop 0
    v_mul_f32 v54, 0x42000000, v54
    v_mul_f32 v55, v53, v54
    v_mov_b32 v56, v54
    s_nop 1
    v_add_f32_dpp v55, v55, v55 quad_perm:[1,0,3,2] row_mask:0xf bank_mask:0xf
    v_add_f32_dpp v56, v56, v56 quad_perm:[1,0,3,2] row_mask:0xf bank_mask:0xf
    s_nop 1
    v_add_f32_dpp v55, v55, v55 quad_perm:[2,3,0,1] row_mask:0xf bank_mask:0xf
    v_add_f32_dpp v56, v56, v56 quad_perm:[2,3,0,1] row_mask:0xf bank_mask:0xf
    s_nop 1
    v_add_f32 v55, 0x43000000, v55
    v_rcp_f32 v56, v56
    s_nop 0
    v_mul_f32 v55, v55, v56
    v_sub_f32 v55, v55, v53
    v_mul_f32 v55, v55, v54
    v_mul_f32 v55, 0x3f800000, v55
    v_add_f32 v55, 0x0, v55
    s_nop 1
    v_readlane_b32 s75, v55, 0
    v_readlane_b32 s76, v55, 1
    v_readlane_b32 s77, v55, 2
    s_nop 3
    v_mov_b32 v53, s75
    v_add_f32 v54, s76, v53
    v_add_f32 v55, s77, v54
    v_add_f32 v53, 0.5, v53
    v_max_f32 v53, 0x41c00000, v53
    v_min_f32 v53, 0x42200000, v53
    v_cvt_u32_f32 v53, v53
    v_add_f32 v54, 0.5, v54
    v_max_f32 v54, 0x42600000, v54
    v_min_f32 v54, 0x42900000, v54
    v_cvt_u32_f32 v54, v54
    v_add_f32 v55, 0.5, v55
    v_max_f32 v55, 0x42b00000, v55
    v_min_f32 v55, 0x42d00000, v55
    v_cvt_u32_f32 v55, v55
    v_lshl_or_b32 v53, v54, 8, v53
    v_lshl_or_b32 v53, v55, 16, v53
    v_mov_b32 v52, 4132
    ds_write_b32 v52, v53
    s_waitcnt lgkmcnt(0)
L_ng_31:
    s_mov_b32 s44, s22
    s_and_b32 s45, s23, 0xffff
    s_mov_b32 s46, 1280
    s_mov_b32 s47, 0x20000
    s_mov_b32 s48, s4
    s_and_b32 s49, s5, 0xffff
    s_mov_b32 s50, 5120
    s_mov_b32 s51, 0x20000
    v_lshlrev_b32 v52, 2, v1
    s_mul_i32 s72, s31, 1280
    buffer_load_dword v36, v52, s[44:47], 0 offen offset:0
    buffer_load_dword v41, v52, s[48:51], s72 offen offset:0
    buffer_load_dword v37, v52, s[44:47], 0 offen offset:256
    buffer_load_dword v42, v52, s[48:51], s72 offen offset:256
    buffer_load_dword v38, v52, s[44:47], 0 offen offset:512
    buffer_load_dword v43, v52, s[48:51], s72 offen offset:512
    buffer_load_dword v39, v52, s[44:47], 0 offen offset:768
    buffer_load_dword v44, v52, s[48:51], s72 offen offset:768
    buffer_load_dword v40, v52, s[44:47], 0 offen offset:1024
    buffer_load_dword v45, v52, s[48:51], s72 offen offset:1024
    s_waitcnt vmcnt(0)
    v_mov_b32 v56, 0
    v_lshlrev_b32 v57, 16, v36
    v_and_b32 v58, 0xffff0000, v36
    v_lshlrev_b32 v59, 16, v41
    v_and_b32 v60, 0xffff0000, v41
    v_fmac_f32 v56, v57, v59
    v_fmac_f32 v56, v58, v60
    v_lshlrev_b32 v57, 16, v37
    v_and_b32 v58, 0xffff0000, v37
    v_lshlrev_b32 v59, 16, v42
    v_and_b32 v60, 0xffff0000, v42
    v_fmac_f32 v56, v57, v59
    v_fmac_f32 v56, v58, v60
    v_lshlrev_b32 v57, 16, v38
    v_and_b32 v58, 0xffff0000, v38
    v_lshlrev_b32 v59, 16, v43
    v_and_b32 v60, 0xffff0000, v43
    v_fmac_f32 v56, v57, v59
    v_fmac_f32 v56, v58, v60
    v_lshlrev_b32 v57, 16, v39
    v_and_b32 v58, 0xffff0000, v39
    v_lshlrev_b32 v59, 16, v44
    v_and_b32 v60, 0xffff0000, v44
    v_fmac_f32 v56, v57, v59
    v_fmac_f32 v56, v58, v60
    v_lshlrev_b32 v57, 16, v40
    v_and_b32 v58, 0xffff0000, v40
    v_lshlrev_b32 v59, 16, v45
    v_and_b32 v60, 0xffff0000, v45
    v_fmac_f32 v56, v57, v59
    v_fmac_f32 v56, v58, v60
    ds_swizzle_b32 v57, v56 offset:0x41f
    s_waitcnt lgkmcnt(0)
    v_add_f32 v56, v56, v57
    ds_swizzle_b32 v57, v56 offset:0x81f
    s_waitcnt lgkmcnt(0)
    v_add_f32 v56, v56, v57
    ds_swizzle_b32 v57, v56 offset:0x101f
    s_waitcnt lgkmcnt(0)
    v_add_f32 v56, v56, v57
    ds_swizzle_b32 v57, v56 offset:0x201f
    s_waitcnt lgkmcnt(0)
    v_add_f32 v56, v56, v57
    ds_swizzle_b32 v57, v56 offset:0x401f
    s_waitcnt lgkmcnt(0)
    v_add_f32 v56, v56, v57
    s_nop 1
    v_readlane_b32 s72, v56, 0
    v_readlane_b32 s73, v56, 32
    s_nop 3
    v_mov_b32 v56, s72
    v_add_f32 v56, s73, v56
    v_mul_f32 v56, 0xbfb8aa3b, v56
    v_exp_f32 v56, v56
    s_nop 0
    v_add_f32 v56, 1.0, v56
    v_rcp_f32 v10, v56
    s_nop 0
    s_cmp_eq_u32 s93, 0
    s_cbranch_scc0 L_ffn
    s_mov_b32 s44, s12
    s_and_b32 s45, s13, 0xffff
    s_mov_b32 s46, 7864320
    s_mov_b32 s47, 0x20000
    v_mul_u32_u24 v52, 1280, v3
    v_lshl_add_u32 v52, v2, 4, v52
    s_mul_i32 s72, s56, 192
    s_mul_i32 s73, s31, 48
    s_add_u32 s72, s72, s73
    s_mul_i32 s72, s72, 1280
    s_lshl_b32 s73, s91, 8
    s_add_u32 s72, s72, s73
    buffer_load_dwordx4 v[64:67], v52, s[44:47], s72 offen nt
    s_add_u32 s72, s72, 5120
    buffer_load_dwordx4 v[68:71], v52, s[44:47], s72 offen nt
    s_add_u32 s72, s72, 5120
    buffer_load_dwordx4 v[72:75], v52, s[44:47], s72 offen nt
    s_add_u32 s72, s72, 5120
    buffer_load_dwordx4 v[76:79], v52, s[44:47], s72 offen nt
    s_add_u32 s72, s72, 5120
    buffer_load_dwordx4 v[80:83], v52, s[44:47], s72 offen nt
    s_add_u32 s72, s72, 5120
    buffer_load_dwordx4 v[84:87], v52, s[44:47], s72 offen nt
    s_add_u32 s72, s72, 5120
    buffer_load_dwordx4 v[88:91], v52, s[44:47], s72 offen nt
    s_add_u32 s72, s72, 5120
    buffer_load_dwordx4 v[92:95], v52, s[44:47], s72 offen nt
    s_add_u32 s72, s72, 5120
    buffer_load_dwordx4 v[96:99], v52, s[44:47], s72 offen nt
    s_add_u32 s72, s72, 5120
    buffer_load_dwordx4 v[100:103], v52, s[44:47], s72 offen nt
    s_add_u32 s72, s72, 5120
    buffer_load_dwordx4 v[104:107], v52, s[44:47], s72 offen nt
    s_add_u32 s72, s72, 5120
    buffer_load_dwordx4 v[108:111], v52, s[44:47], s72 offen nt
    v_mov_b32 v62, 4104
    s_mov_b32 s94, 131072
L_lw_34:
    ds_read_b32 v63, v62
    s_waitcnt lgkmcnt(0)
    v_readfirstlane_b32 s87, v63
    s_nop 3
    s_cmp_ge_u32 s87, 4
    s_cbranch_scc1 L_lwd_35
    s_sub_u32 s94, s94, 1
    s_cmp_eq_u32 s94, 0
    s_cbranch_scc1 L_lwd_35
    s_sleep 2
    s_branch L_lw_34
L_lwd_35:
    s_lshl_b32 s72, s31, 5
    s_add_u32 s72, s72, s56
    s_lshl_b32 s72, s72, 13
    s_add_u32 s73, s72, 4096
    v_lshlrev_b32 v52, 4, v1
    v_min_u32 v53, 31, v1
    v_lshlrev_b32 v53, 4, v53
    v_add_u32 v53, 1024, v53
    v_mov_b32 v54, 1536
    v_lshlrev_b32 v55, 11, v1
    v_add_u32 v55, 1536, v55
    s_mov_b64 exec, 0xf
    s_mov_b32 s94, 131072
L_lp_36:
    buffer_load_dwordx4 v[112:115], v55, s[40:43], s72 offen sc1
    s_waitcnt vmcnt(0)
    v_xor_b32 v112, s14, v114
    v_xor_b32 v113, s15, v115
    v_or_b32 v112, v112, v113
    v_cmp_ne_u32 vcc, 0, v112
    s_cbranch_vccz L_lpd_37
    s_sub_u32 s94, s94, 1
    s_cmp_eq_u32 s94, 0
    s_cbranch_scc1 L_lpd_37
    s_sleep 2
    s_branch L_lp_36
L_lpd_37:
    s_mov_b64 exec, -1
    s_mov_b32 s94, 131072
L_pp_38:
    buffer_load_dwordx4 v[112:115], v52, s[40:43], s72 offen offset:0 sc1
    buffer_load_dwordx4 v[116:119], v53, s[40:43], s72 offen offset:0 sc1
    buffer_load_dwordx4 v[120:123], v54, s[40:43], s72 offen offset:0 sc1
    buffer_load_dwordx4 v[124:127], v52, s[40:43], s72 offen offset:2048 sc1
    buffer_load_dwordx4 v[128:131], v53, s[40:43], s72 offen offset:2048 sc1
    buffer_load_dwordx4 v[132:135], v54, s[40:43], s72 offen offset:2048 sc1
    buffer_load_dwordx4 v[136:139], v52, s[40:43], s73 offen offset:0 sc1
    buffer_load_dwordx4 v[140:143], v53, s[40:43], s73 offen offset:0 sc1
    buffer_load_dwordx4 v[144:147], v54, s[40:43], s73 offen offset:0 sc1
    buffer_load_dwordx4 v[148:151], v52, s[40:43], s73 offen offset:2048 sc1
    buffer_load_dwordx4 v[152:155], v53, s[40:43], s73 offen offset:2048 sc1
    buffer_load_dwordx4 v[156:159], v54, s[40:43], s73 offen offset:2048 sc1
    s_waitcnt vmcnt(0)
    v_xor_b32 v56, s14, v114
    v_xor_b32 v55, s15, v115
    v_or_b32 v55, v55, v56
    v_xor_b32 v56, s14, v118
    v_xor_b32 v57, s15, v119
    v_or3_b32 v55, v55, v56, v57
    v_xor_b32 v56, s14, v122
    v_xor_b32 v57, s15, v123
    v_or3_b32 v55, v55, v56, v57
    v_xor_b32 v56, s14, v126
    v_xor_b32 v57, s15, v127
    v_or3_b32 v55, v55, v56, v57
    v_xor_b32 v56, s14, v130
    v_xor_b32 v57, s15, v131
    v_or3_b32 v55, v55, v56, v57
    v_xor_b32 v56, s14, v134
    v_xor_b32 v57, s15, v135
    v_or3_b32 v55, v55, v56, v57
    v_xor_b32 v56, s14, v138
    v_xor_b32 v57, s15, v139
    v_or3_b32 v55, v55, v56, v57
    v_xor_b32 v56, s14, v142
    v_xor_b32 v57, s15, v143
    v_or3_b32 v55, v55, v56, v57
    v_xor_b32 v56, s14, v146
    v_xor_b32 v57, s15, v147
    v_or3_b32 v55, v55, v56, v57
    v_xor_b32 v56, s14, v150
    v_xor_b32 v57, s15, v151
    v_or3_b32 v55, v55, v56, v57
    v_xor_b32 v56, s14, v154
    v_xor_b32 v57, s15, v155
    v_or3_b32 v55, v55, v56, v57
    v_xor_b32 v56, s14, v158
    v_xor_b32 v57, s15, v159
    v_or3_b32 v55, v55, v56, v57
    v_cmp_ne_u32 vcc, 0, v55
    s_cbranch_vccz L_ppd_39
    s_sub_u32 s94, s94, 1
    s_cmp_eq_u32 s94, 0
    s_cbranch_scc1 L_ppd_39
    s_sleep 2
    s_branch L_pp_38
L_ppd_39:
    v_max_f32 v54, v120, v132
    v_max3_f32 v54, v54, v144, v156
    v_sub_f32 v120, v120, v54
    v_exp_f32 v120, v120
    v_sub_f32 v132, v132, v54
    v_exp_f32 v132, v132
    v_sub_f32 v144, v144, v54
    v_exp_f32 v144, v144
    v_sub_f32 v156, v156, v54
    v_exp_f32 v156, v156
    s_nop 0
    v_mul_f32 v55, v121, v120
    v_fmac_f32 v55, v133, v132
    v_fmac_f32 v55, v145, v144
    v_fmac_f32 v55, v157, v156
    v_rcp_f32 v55, v55
    v_mul_f32 v56, v112, v120
    v_fmac_f32 v56, v124, v132
    v_fmac_f32 v56, v136, v144
    v_fmac_f32 v56, v148, v156
    v_mul_f32 v57, v113, v120
    v_fmac_f32 v57, v125, v132
    v_fmac_f32 v57, v137, v144
    v_fmac_f32 v57, v149, v156
    v_mul_f32 v58, v116, v120
    v_fmac_f32 v58, v128, v132
    v_fmac_f32 v58, v140, v144
    v_fmac_f32 v58, v152, v156
    v_mul_f32 v59, v117, v120
    v_fmac_f32 v59, v129, v132
    v_fmac_f32 v59, v141, v144
    v_fmac_f32 v59, v153, v156
    v_mul_f32 v56, v56, v55
    v_mul_f32 v57, v57, v55
    v_mul_f32 v58, v58, v55
    v_mul_f32 v59, v59, v55
    s_branch L_od
L_ffn:
    v_mul_u32_u24 v52, 3072, v3
    v_lshl_add_u32 v52, v2, 4, v52
    s_mul_i32 s74, s90, 80
    s_mul_i32 s73, s31, 20
    s_add_u32 s74, s74, s73
    s_mul_i32 s72, s74, 3072
    s_lshl_b32 s73, s89, 8
    s_add_u32 s72, s72, s73
    s_mov_b32 s44, s16
    s_and_b32 s45, s17, 0xffff
    s_mov_b32 s46, 1966080
    s_mov_b32 s47, 0x20000
    buffer_load_dwordx4 v[112:115], v52, s[44:47], s72 offen nt
    s_add_u32 s72, s72, 12288
    buffer_load_dwordx4 v[116:119], v52, s[44:47], s72 offen nt
    s_add_u32 s72, s72, 12288
    buffer_load_dwordx4 v[120:123], v52, s[44:47], s72 offen nt
    s_add_u32 s72, s72, 12288
    buffer_load_dwordx4 v[124:127], v52, s[44:47], s72 offen nt
    s_add_u32 s72, s72, 12288
    buffer_load_dwordx4 v[128:131], v52, s[44:47], s72 offen nt
    s_add_u32 s72, s72, 12288
    s_sub_u32 s72, s72, 61440
    s_mov_b32 s52, s18
    s_and_b32 s53, s19, 0xffff
    s_mov_b32 s54, 1966080
    s_mov_b32 s55, 0x20000
    buffer_load_dwordx4 v[132:135], v52, s[52:55], s72 offen nt
    s_add_u32 s72, s72, 12288
    buffer_load_dwordx4 v[136:139], v52, s[52:55], s72 offen nt
    s_add_u32 s72, s72, 12288
    buffer_load_dwordx4 v[140:143], v52, s[52:55], s72 offen nt
    s_add_u32 s72, s72, 12288
    buffer_load_dwordx4 v[144:147], v52, s[52:55], s72 offen nt
    s_add_u32 s72, s72, 12288
    buffer_load_dwordx4 v[148:151], v52, s[52:55], s72 offen nt
    s_add_u32 s72, s72, 12288
    v_lshrrev_b32 v53, 3, v2
    v_mul_u32_u24 v53, 640, v53
    v_add_lshl_u32 v53, v53, v3, 1
    s_lshl_b32 s73, s74, 1
    buffer_load_ushort v160, v53, s[48:51], s73 offen offset:0
    buffer_load_ushort v161, v53, s[48:51], s73 offen offset:2560
    buffer_load_ushort v162, v53, s[48:51], s73 offen offset:8
    buffer_load_ushort v163, v53, s[48:51], s73 offen offset:2568
    buffer_load_ushort v164, v53, s[48:51], s73 offen offset:16
    buffer_load_ushort v165, v53, s[48:51], s73 offen offset:2576
    buffer_load_ushort v166, v53, s[48:51], s73 offen offset:24
    buffer_load_ushort v167, v53, s[48:51], s73 offen offset:2584
    buffer_load_ushort v168, v53, s[48:51], s73 offen offset:32
    buffer_load_ushort v169, v53, s[48:51], s73 offen offset:2592
    s_cmp_eq_u32 s93, 1
    s_cbranch_scc0 L_nd_40
    s_mov_b32 s44, s20
    s_and_b32 s45, s21, 0xffff
    s_mov_b32 s46, 1966080
    s_mov_b32 s47, 0x20000
    v_mul_u32_u24 v53, 1280, v3
    v_lshl_add_u32 v53, v2, 4, v53
    s_mul_i32 s72, s90, 192
    s_mul_i32 s73, s31, 48
    s_add_u32 s72, s72, s73
    s_mul_i32 s72, s72, 1280
    s_lshl_b32 s73, s91, 8
    s_add_u32 s72, s72, s73
    buffer_load_dwordx4 v[64:67], v53, s[44:47], s72 offen nt
    s_add_u32 s72, s72, 5120
    buffer_load_dwordx4 v[68:71], v53, s[44:47], s72 offen nt
    s_add_u32 s72, s72, 5120
    buffer_load_dwordx4 v[72:75], v53, s[44:47], s72 offen nt
    s_add_u32 s72, s72, 5120
    buffer_load_dwordx4 v[76:79], v53, s[44:47], s72 offen nt
    s_add_u32 s72, s72, 5120
    buffer_load_dwordx4 v[80:83], v53, s[44:47], s72 offen nt
    s_add_u32 s72, s72, 5120
    buffer_load_dwordx4 v[84:87], v53, s[44:47], s72 offen nt
    s_add_u32 s72, s72, 5120
    buffer_load_dwordx4 v[88:91], v53, s[44:47], s72 offen nt
    s_add_u32 s72, s72, 5120
    buffer_load_dwordx4 v[92:95], v53, s[44:47], s72 offen nt
    s_add_u32 s72, s72, 5120
    buffer_load_dwordx4 v[96:99], v53, s[44:47], s72 offen nt
    s_add_u32 s72, s72, 5120
    buffer_load_dwordx4 v[100:103], v53, s[44:47], s72 offen nt
    s_add_u32 s72, s72, 5120
    buffer_load_dwordx4 v[104:107], v53, s[44:47], s72 offen nt
    s_add_u32 s72, s72, 5120
    buffer_load_dwordx4 v[108:111], v53, s[44:47], s72 offen nt
L_nd_40:
    s_waitcnt vmcnt(0)
    v_lshl_or_b32 v160, v160, 16, v160
    v_lshl_or_b32 v161, v161, 16, v161
    v_lshl_or_b32 v162, v162, 16, v162
    v_lshl_or_b32 v163, v163, 16, v163
    v_lshl_or_b32 v164, v164, 16, v164
    v_lshl_or_b32 v165, v165, 16, v165
    v_lshl_or_b32 v166, v166, 16, v166
    v_lshl_or_b32 v167, v167, 16, v167
    v_lshl_or_b32 v168, v168, 16, v168
    v_lshl_or_b32 v169, v169, 16, v169
    v_and_b32 v44, v160, v6
    v_and_b32 v45, v160, v7
    v_and_b32 v46, v160, v8
    v_and_b32 v47, v160, v9
    v_and_b32 v48, v161, v6
    v_and_b32 v49, v161, v7
    v_and_b32 v50, v161, v8
    v_and_b32 v51, v161, v9
    s_nop 1
    v_mfma_f32_16x16x32_bf16 v[12:15], v[112:115], v[44:47], 0
    v_mfma_f32_16x16x32_bf16 v[16:19], v[112:115], v[48:51], 0
    v_mfma_f32_16x16x32_bf16 v[20:23], v[132:135], v[44:47], 0
    v_mfma_f32_16x16x32_bf16 v[24:27], v[132:135], v[48:51], 0
    v_and_b32 v44, v162, v6
    v_and_b32 v45, v162, v7
    v_and_b32 v46, v162, v8
    v_and_b32 v47, v162, v9
    v_and_b32 v48, v163, v6
    v_and_b32 v49, v163, v7
    v_and_b32 v50, v163, v8
    v_and_b32 v51, v163, v9
    s_nop 1
    v_mfma_f32_16x16x32_bf16 v[12:15], v[116:119], v[44:47], v[12:15]
    v_mfma_f32_16x16x32_bf16 v[16:19], v[116:119], v[48:51], v[16:19]
    v_mfma_f32_16x16x32_bf16 v[20:23], v[136:139], v[44:47], v[20:23]
    v_mfma_f32_16x16x32_bf16 v[24:27], v[136:139], v[48:51], v[24:27]
    v_and_b32 v44, v164, v6
    v_and_b32 v45, v164, v7
    v_and_b32 v46, v164, v8
    v_and_b32 v47, v164, v9
    v_and_b32 v48, v165, v6
    v_and_b32 v49, v165, v7
    v_and_b32 v50, v165, v8
    v_and_b32 v51, v165, v9
    s_nop 1
    v_mfma_f32_16x16x32_bf16 v[12:15], v[120:123], v[44:47], v[12:15]
    v_mfma_f32_16x16x32_bf16 v[16:19], v[120:123], v[48:51], v[16:19]
    v_mfma_f32_16x16x32_bf16 v[20:23], v[140:143], v[44:47], v[20:23]
    v_mfma_f32_16x16x32_bf16 v[24:27], v[140:143], v[48:51], v[24:27]
    v_and_b32 v44, v166, v6
    v_and_b32 v45, v166, v7
    v_and_b32 v46, v166, v8
    v_and_b32 v47, v166, v9
    v_and_b32 v48, v167, v6
    v_and_b32 v49, v167, v7
    v_and_b32 v50, v167, v8
    v_and_b32 v51, v167, v9
    s_nop 1
    v_mfma_f32_16x16x32_bf16 v[12:15], v[124:127], v[44:47], v[12:15]
    v_mfma_f32_16x16x32_bf16 v[16:19], v[124:127], v[48:51], v[16:19]
    v_mfma_f32_16x16x32_bf16 v[20:23], v[144:147], v[44:47], v[20:23]
    v_mfma_f32_16x16x32_bf16 v[24:27], v[144:147], v[48:51], v[24:27]
    v_and_b32 v44, v168, v6
    v_and_b32 v45, v168, v7
    v_and_b32 v46, v168, v8
    v_and_b32 v47, v168, v9
    v_and_b32 v48, v169, v6
    v_and_b32 v49, v169, v7
    v_and_b32 v50, v169, v8
    v_and_b32 v51, v169, v9
    s_nop 1
    v_mfma_f32_16x16x32_bf16 v[12:15], v[128:131], v[44:47], v[12:15]
    v_mfma_f32_16x16x32_bf16 v[16:19], v[128:131], v[48:51], v[16:19]
    v_mfma_f32_16x16x32_bf16 v[20:23], v[148:151], v[44:47], v[20:23]
    v_mfma_f32_16x16x32_bf16 v[24:27], v[148:151], v[48:51], v[24:27]
    s_nop 7
    s_nop 3
    s_lshl_b32 s72, s31, 12
    v_lshlrev_b32 v52, 4, v1
    v_add_u32 v52, s72, v52
    ds_write_b128 v52, v[12:15] offset:30976
    ds_write_b128 v52, v[16:19] offset:32000
    ds_write_b128 v52, v[20:23] offset:33024
    ds_write_b128 v52, v[24:27] offset:34048
    s_waitcnt lgkmcnt(0)
    v_mov_b32 v62, 4116
    v_mov_b32 v63, 1
    s_mov_b64 exec, 1
    ds_add_u32 v62, v63
    s_mov_b64 exec, -1
    v_mov_b32 v62, 4116
    s_mov_b32 s94, 131072
L_lw_41:
    ds_read_b32 v63, v62
    s_waitcnt lgkmcnt(0)
    v_readfirstlane_b32 s87, v63
    s_nop 3
    s_cmp_ge_u32 s87, 4
    s_cbranch_scc1 L_lwd_42
    s_sub_u32 s94, s94, 1
    s_cmp_eq_u32 s94, 0
    s_cbranch_scc1 L_lwd_42
    s_sleep 1
    s_branch L_lw_41
L_lwd_42:
    v_and_b32 v52, 3, v1
    v_lshlrev_b32 v52, 1, v52
    v_lshl_add_u32 v52, v3, 4, v52
    v_lshlrev_b32 v52, 4, v52
    v_bfe_u32 v61, v1, 2, 2
    v_lshl_add_u32 v52, v61, 2, v52
    s_and_b32 s72, s31, 1
    s_lshl_b32 s72, s72, 7
    s_lshr_b32 s73, s31, 1
    s_lshl_b32 s73, s73, 10
    s_add_u32 s72, s72, s73
    v_add_u32 v52, s72, v52
    ds_read_b32 v36, v52 offset:30976
    ds_read_b32 v37, v52 offset:35072
    ds_read_b32 v38, v52 offset:39168
    ds_read_b32 v39, v52 offset:43264
    ds_read_b32 v40, v52 offset:30992
    ds_read_b32 v41, v52 offset:35088
    ds_read_b32 v42, v52 offset:39184
    ds_read_b32 v43, v52 offset:43280
    ds_read_b32 v44, v52 offset:33024
    ds_read_b32 v45, v52 offset:37120
    ds_read_b32 v46, v52 offset:41216
    ds_read_b32 v47, v52 offset:45312
    ds_read_b32 v48, v52 offset:33040
    ds_read_b32 v49, v52 offset:37136
    ds_read_b32 v50, v52 offset:41232
    ds_read_b32 v51, v52 offset:45328
    s_waitcnt lgkmcnt(0)
    s_lshl_b32 s72, s89, 3
    s_add_u32 s72, s72, s90
    s_lshl_b32 s72, s72, 13
    s_lshl_b32 s73, s31, 10
    s_add_u32 s72, s72, s73
    s_add_u32 s72, s72, 1048576
    v_lshlrev_b32 v53, 4, v1
    v_add_f32 v36, v36, v37
    v_add_f32 v38, v38, v39
    v_add_f32 v112, v36, v38
    v_add_f32 v40, v40, v41
    v_add_f32 v42, v42, v43
    v_add_f32 v113, v40, v42
    s_add_u32 s73, s72, 0
    v_mov_b32 v114, s14
    v_mov_b32 v115, s15
    buffer_store_dwordx4 v[112:115], v53, s[40:43], s73 offen offset:0 sc1
    v_add_f32 v44, v44, v45
    v_add_f32 v46, v46, v47
    v_add_f32 v116, v44, v46
    v_add_f32 v48, v48, v49
    v_add_f32 v50, v50, v51
    v_add_f32 v117, v48, v50
    s_add_u32 s73, s72, 4096
    v_mov_b32 v118, s14
    v_mov_b32 v119, s15
    buffer_store_dwordx4 v[116:119], v53, s[40:43], s73 offen offset:0 sc1
    s_cmp_eq_u32 s93, 1
    s_cbranch_scc1 L_ffn2
    s_cmp_ge_u32 s89, 8
    s_cbranch_scc1 L_end
    s_mul_i32 s77, s90, 3
    s_add_u32 s77, s77, s89
    s_sub_u32 s77, s77, 5
    s_lshr_b32 s72, s77, 1
    s_lshl_b32 s72, s72, 16
    s_and_b32 s73, s77, 1
    s_lshl_b32 s73, s73, 9
    s_add_u32 s72, s72, s73
    s_lshl_b32 s73, s31, 10
    s_add_u32 s72, s72, s73
    s_add_u32 s72, s72, 1048576
    v_and_b32 v52, 31, v1
    v_lshlrev_b32 v52, 4, v52
    v_lshrrev_b32 v53, 5, v1
    v_lshl_add_u32 v53, v53, 12, v52
    v_lshlrev_b32 v55, 13, v1
    s_mov_b64 exec, 0xff
    s_mov_b32 s94, 131072
L_lp_43:
    buffer_load_dwordx4 v[112:115], v55, s[40:43], s72 offen sc1
    s_waitcnt vmcnt(0)
    v_xor_b32 v112, s14, v114
    v_xor_b32 v113, s15, v115
    v_or_b32 v112, v112, v113
    v_cmp_ne_u32 vcc, 0, v112
    s_cbranch_vccz L_lpd_44
    s_sub_u32 s94, s94, 1
    s_cmp_eq_u32 s94, 0
    s_cbranch_scc1 L_lpd_44
    s_sleep 32
    s_branch L_lp_43
L_lpd_44:
    s_mov_b64 exec, -1
    s_mov_b32 s94, 131072
L_hp_45:
    s_mov_b32 s73, s72
    buffer_load_dwordx4 v[112:115], v53, s[40:43], s73 offen sc1
    s_add_u32 s73, s73, 8192
    buffer_load_dwordx4 v[116:119], v53, s[40:43], s73 offen sc1
    s_add_u32 s73, s73, 8192
    buffer_load_dwordx4 v[120:123], v53, s[40:43], s73 offen sc1
    s_add_u32 s73, s73, 8192
    buffer_load_dwordx4 v[124:127], v53, s[40:43], s73 offen sc1
    s_add_u32 s73, s73, 8192
    buffer_load_dwordx4 v[128:131], v53, s[40:43], s73 offen sc1
    s_add_u32 s73, s73, 8192
    buffer_load_dwordx4 v[132:135], v53, s[40:43], s73 offen sc1
    s_add_u32 s73, s73, 8192
    buffer_load_dwordx4 v[136:139], v53, s[40:43], s73 offen sc1
    s_add_u32 s73, s73, 8192
    buffer_load_dwordx4 v[140:143], v53, s[40:43], s73 offen sc1
    s_waitcnt vmcnt(0)
    v_xor_b32 v56, s14, v114
    v_xor_b32 v55, s15, v115
    v_or_b32 v55, v55, v56
    v_xor_b32 v56, s14, v118
    v_xor_b32 v57, s15, v119
    v_or3_b32 v55, v55, v56, v57
    v_xor_b32 v56, s14, v122
    v_xor_b32 v57, s15, v123
    v_or3_b32 v55, v55, v56, v57
    v_xor_b32 v56, s14, v126
    v_xor_b32 v57, s15, v127
    v_or3_b32 v55, v55, v56, v57
    v_xor_b32 v56, s14, v130
    v_xor_b32 v57, s15, v131
    v_or3_b32 v55, v55, v56, v57
    v_xor_b32 v56, s14, v134
    v_xor_b32 v57, s15, v135
    v_or3_b32 v55, v55, v56, v57
    v_xor_b32 v56, s14, v138
    v_xor_b32 v57, s15, v139
    v_or3_b32 v55, v55, v56, v57
    v_xor_b32 v56, s14, v142
    v_xor_b32 v57, s15, v143
    v_or3_b32 v55, v55, v56, v57
    v_cmp_ne_u32 vcc, 0, v55
    s_cbranch_vccz L_hpd_46
    s_sub_u32 s94, s94, 1
    s_cmp_eq_u32 s94, 0
    s_cbranch_scc1 L_hpd_46
    s_sleep 16
    s_branch L_hp_45
L_hpd_46:
    v_add_f32 v112, v112, v116
    v_add_f32 v112, v112, v120
    v_add_f32 v112, v112, v124
    v_add_f32 v112, v112, v128
    v_add_f32 v112, v112, v132
    v_add_f32 v112, v112, v136
    v_add_f32 v112, v112, v140
    v_add_f32 v113, v113, v117
    v_add_f32 v113, v113, v121
    v_add_f32 v113, v113, v125
    v_add_f32 v113, v113, v129
    v_add_f32 v113, v113, v133
    v_add_f32 v113, v113, v137
    v_add_f32 v113, v113, v141
    v_add_u32 v54, 32, v1
    v_and_b32 v54, 63, v54
    v_lshlrev_b32 v54, 2, v54
    ds_bpermute_b32 v116, v54, v112
    ds_bpermute_b32 v117, v54, v113
    s_waitcnt lgkmcnt(0)
    v_mul_f32 v54, v112, v112
    v_mul_f32 v54, 0x3d372713, v54
    v_add_f32 v54, 1.0, v54
    v_mul_f32 v54, v54, v112
    v_mul_f32 v54, 0xc0135761, v54
    v_exp_f32 v54, v54
    s_nop 0
    v_add_f32 v54, 1.0, v54
    v_rcp_f32 v54, v54
    s_nop 0
    v_mul_f32 v54, v54, v112
    v_mul_f32 v120, v54, v116
    v_mul_f32 v54, v113, v113
    v_mul_f32 v54, 0x3d372713, v54
    v_add_f32 v54, 1.0, v54
    v_mul_f32 v54, v54, v113
    v_mul_f32 v54, 0xc0135761, v54
    v_exp_f32 v54, v54
    s_nop 0
    v_add_f32 v54, 1.0, v54
    v_rcp_f32 v54, v54
    s_nop 0
    v_mul_f32 v54, v54, v113
    v_mul_f32 v121, v54, v117
    s_lshl_b32 s72, s77, 2
    s_add_u32 s72, s72, s31
    s_lshl_b32 s72, s72, 9
    s_add_u32 s72, s72, 4390912
    s_mov_b32 exec_hi, 0
    v_mov_b32 v122, s14
    v_mov_b32 v123, s15
    buffer_store_dwordx4 v[120:123], v52, s[40:43], s72 offen offset:0 sc1
    s_endpgm
L_ffn2:
    s_mul_i32 s72, s90, 12
    s_add_u32 s72, s72, s31
    s_lshl_b32 s72, s72, 9
    s_add_u32 s72, s72, 4390912
    v_and_b32 v52, 31, v1
    v_lshlrev_b32 v52, 4, v52
    v_lshrrev_b32 v53, 5, v1
    v_lshl_add_u32 v53, v53, 11, v52
    v_add_u32 v54, 4096, v52
    s_mov_b32 s94, 131072
L_h2_47:
    buffer_load_dwordx4 v[112:115], v53, s[40:43], s72 offen sc1
    buffer_load_dwordx4 v[116:119], v54, s[40:43], s72 offen sc1
    s_waitcnt vmcnt(0)
    v_xor_b32 v56, s14, v114
    v_xor_b32 v55, s15, v115
    v_or_b32 v55, v55, v56
    v_xor_b32 v56, s14, v118
    v_xor_b32 v57, s15, v119
    v_or3_b32 v55, v55, v56, v57
    v_cmp_ne_u32 vcc, 0, v55
    s_cbranch_vccz L_h2d_48
    s_sub_u32 s94, s94, 1
    s_cmp_eq_u32 s94, 0
    s_cbranch_scc1 L_h2d_48
    s_sleep 32
    s_branch L_h2_47
L_h2d_48:
    v_mov_b32 v56, v112
    v_mov_b32 v57, v113
    v_mov_b32 v58, v116
    v_mov_b32 v59, v117
    v_sub_f32 v10, 1.0, v10
L_od:
    s_mul_i32 s72, s31, 768
    v_lshlrev_b32 v52, 3, v1
    v_add_u32 v52, s72, v52
    v_cvt_pk_bf16_f32 v56, v56, v56
    v_cvt_pk_bf16_f32 v57, v57, v57
    v_cvt_pk_bf16_f32 v58, v58, v58
    v_cvt_pk_bf16_f32 v59, v59, v59
    ds_write_b64 v52, v[56:57] offset:1024
    s_mov_b32 exec_hi, 0
    ds_write_b64 v52, v[58:59] offset:1536
    s_mov_b64 exec, -1
    s_waitcnt lgkmcnt(0)
    v_mov_b32 v62, 4108
    v_mov_b32 v63, 1
    s_mov_b64 exec, 1
    ds_add_u32 v62, v63
    s_mov_b64 exec, -1
    v_mov_b32 v62, 4108
    s_mov_b32 s94, 131072
L_lw_49:
    ds_read_b32 v63, v62
    s_waitcnt lgkmcnt(0)
    v_readfirstlane_b32 s87, v63
    s_nop 3
    s_cmp_ge_u32 s87, 4
    s_cbranch_scc1 L_lwd_50
    s_sub_u32 s94, s94, 1
    s_cmp_eq_u32 s94, 0
    s_cbranch_scc1 L_lwd_50
    s_sleep 1
    s_branch L_lw_49
L_lwd_50:
    v_lshrrev_b32 v52, 3, v2
    v_mul_u32_u24 v52, 192, v52
    v_add_u32 v52, v52, v3
    s_mul_i32 s72, s31, 48
    v_add_u32 v52, s72, v52
    v_lshlrev_b32 v52, 2, v52
    ds_read_b32 v160, v52 offset:1024
    ds_read_b32 v161, v52 offset:2560
    ds_read_b32 v162, v52 offset:1040
    ds_read_b32 v163, v52 offset:2576
    ds_read_b32 v164, v52 offset:1056
    ds_read_b32 v165, v52 offset:2592
    ds_read_b32 v166, v52 offset:1072
    ds_read_b32 v167, v52 offset:2608
    ds_read_b32 v168, v52 offset:1088
    ds_read_b32 v169, v52 offset:2624
    ds_read_b32 v170, v52 offset:1104
    ds_read_b32 v171, v52 offset:2640
    ds_read_b32 v172, v52 offset:1120
    ds_read_b32 v173, v52 offset:2656
    ds_read_b32 v174, v52 offset:1136
    ds_read_b32 v175, v52 offset:2672
    ds_read_b32 v176, v52 offset:1152
    ds_read_b32 v177, v52 offset:2688
    ds_read_b32 v178, v52 offset:1168
    ds_read_b32 v179, v52 offset:2704
    ds_read_b32 v180, v52 offset:1184
    ds_read_b32 v181, v52 offset:2720
    ds_read_b32 v182, v52 offset:1200
    ds_read_b32 v183, v52 offset:2736
    s_waitcnt vmcnt(0) lgkmcnt(0)
    v_and_b32 v24, v160, v6
    v_and_b32 v25, v160, v7
    v_and_b32 v26, v160, v8
    v_and_b32 v27, v160, v9
    v_and_b32 v28, v161, v6
    v_and_b32 v29, v161, v7
    v_and_b32 v30, v161, v8
    v_and_b32 v31, v161, v9
    s_nop 1
    v_mfma_f32_16x16x32_bf16 v[12:15], v[64:67], v[24:27], 0
    v_mfma_f32_16x16x32_bf16 v[16:19], v[64:67], v[28:31], 0
    v_and_b32 v32, v162, v6
    v_and_b32 v33, v162, v7
    v_and_b32 v34, v162, v8
    v_and_b32 v35, v162, v9
    v_and_b32 v36, v163, v6
    v_and_b32 v37, v163, v7
    v_and_b32 v38, v163, v8
    v_and_b32 v39, v163, v9
    s_nop 1
    v_mfma_f32_16x16x32_bf16 v[12:15], v[68:71], v[32:35], v[12:15]
    v_mfma_f32_16x16x32_bf16 v[16:19], v[68:71], v[36:39], v[16:19]
    v_and_b32 v24, v164, v6
    v_and_b32 v25, v164, v7
    v_and_b32 v26, v164, v8
    v_and_b32 v27, v164, v9
    v_and_b32 v28, v165, v6
    v_and_b32 v29, v165, v7
    v_and_b32 v30, v165, v8
    v_and_b32 v31, v165, v9
    s_nop 1
    v_mfma_f32_16x16x32_bf16 v[12:15], v[72:75], v[24:27], v[12:15]
    v_mfma_f32_16x16x32_bf16 v[16:19], v[72:75], v[28:31], v[16:19]
    v_and_b32 v32, v166, v6
    v_and_b32 v33, v166, v7
    v_and_b32 v34, v166, v8
    v_and_b32 v35, v166, v9
    v_and_b32 v36, v167, v6
    v_and_b32 v37, v167, v7
    v_and_b32 v38, v167, v8
    v_and_b32 v39, v167, v9
    s_nop 1
    v_mfma_f32_16x16x32_bf16 v[12:15], v[76:79], v[32:35], v[12:15]
    v_mfma_f32_16x16x32_bf16 v[16:19], v[76:79], v[36:39], v[16:19]
    v_and_b32 v24, v168, v6
    v_and_b32 v25, v168, v7
    v_and_b32 v26, v168, v8
    v_and_b32 v27, v168, v9
    v_and_b32 v28, v169, v6
    v_and_b32 v29, v169, v7
    v_and_b32 v30, v169, v8
    v_and_b32 v31, v169, v9
    s_nop 1
    v_mfma_f32_16x16x32_bf16 v[12:15], v[80:83], v[24:27], v[12:15]
    v_mfma_f32_16x16x32_bf16 v[16:19], v[80:83], v[28:31], v[16:19]
    v_and_b32 v32, v170, v6
    v_and_b32 v33, v170, v7
    v_and_b32 v34, v170, v8
    v_and_b32 v35, v170, v9
    v_and_b32 v36, v171, v6
    v_and_b32 v37, v171, v7
    v_and_b32 v38, v171, v8
    v_and_b32 v39, v171, v9
    s_nop 1
    v_mfma_f32_16x16x32_bf16 v[12:15], v[84:87], v[32:35], v[12:15]
    v_mfma_f32_16x16x32_bf16 v[16:19], v[84:87], v[36:39], v[16:19]
    v_and_b32 v24, v172, v6
    v_and_b32 v25, v172, v7
    v_and_b32 v26, v172, v8
    v_and_b32 v27, v172, v9
    v_and_b32 v28, v173, v6
    v_and_b32 v29, v173, v7
    v_and_b32 v30, v173, v8
    v_and_b32 v31, v173, v9
    s_nop 1
    v_mfma_f32_16x16x32_bf16 v[12:15], v[88:91], v[24:27], v[12:15]
    v_mfma_f32_16x16x32_bf16 v[16:19], v[88:91], v[28:31], v[16:19]
    v_and_b32 v32, v174, v6
    v_and_b32 v33, v174, v7
    v_and_b32 v34, v174, v8
    v_and_b32 v35, v174, v9
    v_and_b32 v36, v175, v6
    v_and_b32 v37, v175, v7
    v_and_b32 v38, v175, v8
    v_and_b32 v39, v175, v9
    s_nop 1
    v_mfma_f32_16x16x32_bf16 v[12:15], v[92:95], v[32:35], v[12:15]
    v_mfma_f32_16x16x32_bf16 v[16:19], v[92:95], v[36:39], v[16:19]
    v_and_b32 v24, v176, v6
    v_and_b32 v25, v176, v7
    v_and_b32 v26, v176, v8
    v_and_b32 v27, v176, v9
    v_and_b32 v28, v177, v6
    v_and_b32 v29, v177, v7
    v_and_b32 v30, v177, v8
    v_and_b32 v31, v177, v9
    s_nop 1
    v_mfma_f32_16x16x32_bf16 v[12:15], v[96:99], v[24:27], v[12:15]
    v_mfma_f32_16x16x32_bf16 v[16:19], v[96:99], v[28:31], v[16:19]
    v_and_b32 v32, v178, v6
    v_and_b32 v33, v178, v7
    v_and_b32 v34, v178, v8
    v_and_b32 v35, v178, v9
    v_and_b32 v36, v179, v6
    v_and_b32 v37, v179, v7
    v_and_b32 v38, v179, v8
    v_and_b32 v39, v179, v9
    s_nop 1
    v_mfma_f32_16x16x32_bf16 v[12:15], v[100:103], v[32:35], v[12:15]
    v_mfma_f32_16x16x32_bf16 v[16:19], v[100:103], v[36:39], v[16:19]
    v_and_b32 v24, v180, v6
    v_and_b32 v25, v180, v7
    v_and_b32 v26, v180, v8
    v_and_b32 v27, v180, v9
    v_and_b32 v28, v181, v6
    v_and_b32 v29, v181, v7
    v_and_b32 v30, v181, v8
    v_and_b32 v31, v181, v9
    s_nop 1
    v_mfma_f32_16x16x32_bf16 v[12:15], v[104:107], v[24:27], v[12:15]
    v_mfma_f32_16x16x32_bf16 v[16:19], v[104:107], v[28:31], v[16:19]
    v_and_b32 v32, v182, v6
    v_and_b32 v33, v182, v7
    v_and_b32 v34, v182, v8
    v_and_b32 v35, v182, v9
    v_and_b32 v36, v183, v6
    v_and_b32 v37, v183, v7
    v_and_b32 v38, v183, v8
    v_and_b32 v39, v183, v9
    s_nop 1
    v_mfma_f32_16x16x32_bf16 v[12:15], v[108:111], v[32:35], v[12:15]
    v_mfma_f32_16x16x32_bf16 v[16:19], v[108:111], v[36:39], v[16:19]
    s_nop 7
    s_nop 3
    s_lshl_b32 s72, s31, 11
    v_lshlrev_b32 v52, 4, v1
    v_add_u32 v52, s72, v52
    ds_write_b128 v52, v[12:15] offset:47360
    ds_write_b128 v52, v[16:19] offset:48384
    s_waitcnt lgkmcnt(0)
    v_mov_b32 v62, 4112
    v_mov_b32 v63, 1
    s_mov_b64 exec, 1
    ds_add_u32 v62, v63
    s_mov_b64 exec, -1
    v_mov_b32 v62, 4112
    s_mov_b32 s94, 131072
L_lw_51:
    ds_read_b32 v63, v62
    s_waitcnt lgkmcnt(0)
    v_readfirstlane_b32 s87, v63
    s_nop 3
    s_cmp_ge_u32 s87, 4
    s_cbranch_scc1 L_lwd_52
    s_sub_u32 s94, s94, 1
    s_cmp_eq_u32 s94, 0
    s_cbranch_scc1 L_lwd_52
    s_sleep 1
    s_branch L_lw_51
L_lwd_52:
    v_and_b32 v52, 3, v1
    v_lshlrev_b32 v52, 1, v52
    v_lshl_add_u32 v52, v3, 4, v52
    v_lshlrev_b32 v52, 4, v52
    v_bfe_u32 v61, v1, 2, 2
    v_lshl_add_u32 v52, v61, 2, v52
    s_and_b32 s72, s31, 1
    s_lshl_b32 s72, s72, 7
    s_lshr_b32 s73, s31, 1
    s_lshl_b32 s73, s73, 10
    s_add_u32 s72, s72, s73
    v_add_u32 v52, s72, v52
    ds_read_b32 v36, v52 offset:47360
    ds_read_b32 v37, v52 offset:49408
    ds_read_b32 v38, v52 offset:51456
    ds_read_b32 v39, v52 offset:53504
    ds_read_b32 v40, v52 offset:47376
    ds_read_b32 v41, v52 offset:49424
    ds_read_b32 v42, v52 offset:51472
    ds_read_b32 v43, v52 offset:53520
    s_waitcnt lgkmcnt(0)
    s_mul_i32 s72, s91, 40
    s_add_u32 s72, s72, s92
    s_lshl_b32 s72, s72, 12
    s_lshl_b32 s73, s31, 10
    s_add_u32 s72, s72, s73
    s_add_u32 s72, s72, 1835008
    v_lshlrev_b32 v53, 4, v1
    v_add_f32 v36, v36, v37
    v_add_f32 v38, v38, v39
    v_add_f32 v36, v36, v38
    v_mul_f32 v112, v36, v10
    v_add_f32 v40, v40, v41
    v_add_f32 v42, v42, v43
    v_add_f32 v40, v40, v42
    v_mul_f32 v113, v40, v10
    v_mov_b32 v114, s14
    v_mov_b32 v115, s15
    buffer_store_dwordx4 v[112:115], v53, s[40:43], s72 offen offset:0 sc1
    s_cmp_eq_u32 s93, 0
    s_cbranch_scc0 L_end
    s_cmp_eq_u32 s31, 0
    s_cbranch_scc0 L_end
    s_lshr_b32 s72, s56, 3
    s_and_b32 s73, s56, 7
    s_mul_i32 s74, s91, 163840
    s_lshl_b32 s75, s72, 10
    s_add_u32 s74, s74, s75
    s_lshl_b32 s75, s73, 7
    s_add_u32 s74, s74, s75
    s_add_u32 s74, s74, 1835008
    v_lshrrev_b32 v52, 3, v1
    v_lshlrev_b32 v52, 12, v52
    v_and_b32 v53, 7, v1
    v_lshl_add_u32 v52, v53, 4, v52
    s_mov_b32 s94, 131072
L_fp_53:
    s_mov_b32 s76, s74
    buffer_load_dwordx4 v[128:131], v52, s[40:43], s76 offen sc1
    s_add_u32 s76, s76, 32768
    buffer_load_dwordx4 v[132:135], v52, s[40:43], s76 offen sc1
    s_add_u32 s76, s76, 32768
    buffer_load_dwordx4 v[136:139], v52, s[40:43], s76 offen sc1
    s_add_u32 s76, s76, 32768
    buffer_load_dwordx4 v[140:143], v52, s[40:43], s76 offen sc1
    s_add_u32 s76, s76, 32768
    buffer_load_dwordx4 v[144:147], v52, s[40:43], s76 offen sc1
    s_waitcnt vmcnt(0)
    v_xor_b32 v55, s14, v130
    v_xor_b32 v54, s15, v131
    v_or_b32 v54, v54, v55
    v_xor_b32 v55, s14, v134
    v_xor_b32 v56, s15, v135
    v_or3_b32 v54, v54, v55, v56
    v_xor_b32 v55, s14, v138
    v_xor_b32 v56, s15, v139
    v_or3_b32 v54, v54, v55, v56
    v_xor_b32 v55, s14, v142
    v_xor_b32 v56, s15, v143
    v_or3_b32 v54, v54, v55, v56
    v_xor_b32 v55, s14, v146
    v_xor_b32 v56, s15, v147
    v_or3_b32 v54, v54, v55, v56
    v_cmp_ne_u32 vcc, 0, v54
    s_cbranch_vccz L_fpd_54
    s_sub_u32 s94, s94, 1
    s_cmp_eq_u32 s94, 0
    s_cbranch_scc1 L_fpd_54
    s_sleep 1
    s_branch L_fp_53
L_fpd_54:
    v_add_f32 v128, v128, v132
    v_add_f32 v129, v129, v133
    v_add_f32 v128, v128, v136
    v_add_f32 v129, v129, v137
    v_add_f32 v128, v128, v140
    v_add_f32 v129, v129, v141
    v_add_f32 v128, v128, v144
    v_add_f32 v129, v129, v145
    v_xor_b32 v54, 8, v1
    v_lshlrev_b32 v54, 2, v54
    ds_bpermute_b32 v55, v54, v128
    ds_bpermute_b32 v56, v54, v129
    s_waitcnt lgkmcnt(0)
    v_add_f32 v128, v128, v55
    v_add_f32 v129, v129, v56
    v_xor_b32 v54, 16, v1
    v_lshlrev_b32 v54, 2, v54
    ds_bpermute_b32 v55, v54, v128
    ds_bpermute_b32 v56, v54, v129
    s_waitcnt lgkmcnt(0)
    v_add_f32 v128, v128, v55
    v_add_f32 v129, v129, v56
    v_xor_b32 v54, 32, v1
    v_lshlrev_b32 v54, 2, v54
    ds_bpermute_b32 v55, v54, v128
    ds_bpermute_b32 v56, v54, v129
    s_waitcnt lgkmcnt(0)
    v_add_f32 v128, v128, v55
    v_add_f32 v129, v129, v56
    v_cvt_pk_bf16_f32 v128, v128, v129
    s_mov_b32 s44, s24
    s_and_b32 s45, s25, 0xffff
    s_mov_b32 s46, 5120
    s_mov_b32 s47, 0x20000
    s_mul_i32 s72, s72, 640
    s_lshl_b32 s75, s91, 7
    s_add_u32 s72, s72, s75
    s_lshl_b32 s73, s73, 4
    s_add_u32 s72, s72, s73
    s_lshl_b32 s72, s72, 1
    v_lshlrev_b32 v52, 2, v1
    s_mov_b64 exec, 0xff
    buffer_store_dword v128, v52, s[44:47], s72 offen
    s_mov_b64 exec, -1
    s_cmp_eq_u32 s2, 0
    s_cbranch_scc0 L_end
    v_mov_b32 v52, s14
    v_mov_b32 v53, s15
    v_mov_b32 v54, 4259840
    s_mov_b64 exec, 1
    buffer_store_dwordx2 v[52:53], v54, s[40:43], 0 offen sc1
L_end:
    s_endpgm
.section .rodata,"a"
.p2align 6
.amdhsa_kernel gated_mix__mha_block_cached__glu_gated_geglu__decode_kernel
  .amdhsa_next_free_vgpr 256
  .amdhsa_next_free_sgpr 102
  .amdhsa_accum_offset 256
  .amdhsa_group_segment_fixed_size 0
  .amdhsa_kernarg_size 104
  .amdhsa_user_sgpr_count 2
  .amdhsa_user_sgpr_kernarg_segment_ptr 1
  .amdhsa_system_sgpr_workgroup_id_x 1
.end_amdhsa_kernel
```
